```python
import torch

def _softmax(x, axis=-1):
    return torch.softmax(x, dim=axis)
def _gelu(x):
    return torch.nn.functional.gelu(x, approximate="tanh")
def _silu(x):
    return torch.nn.functional.silu(x)
def _sigmoid(x):
    return torch.sigmoid(x)
def _layernorm(x, axis=-1, eps=1e-5):
    m = x.mean(dim=axis, keepdim=True)
    v = x.var(dim=axis, keepdim=True, unbiased=False)
    return (x - m) / torch.sqrt(v + eps)
def _scatter_add(tgt, idx, src, axis=0):
    return tgt.clone().index_add_(axis, idx, src)
def _segment_sum(src, seg, n):
    out = torch.zeros((n,) + src.shape[1:], dtype=src.dtype)
    return out.index_add_(0, seg, src)
def _pad(x, pw):
    flat = tuple(v for pair in reversed(pw) for v in pair)
    return torch.nn.functional.pad(x, flat)

kernel_name = 'interleave_layers__ssm_conv_h3__ssm_conv_h3__prompt'

def setup_inputs():

    _w = (lambda a: (lambda t: t.to(torch.bfloat16) if t.is_floating_point() else t)(torch.as_tensor(a)))
    def _A_setup():
        B, S, D = 1, 2048, 576
        ks = 4
        return {
            "q": _w((lambda *s: torch.randn(*s, dtype=torch.bfloat16) * 0.05)(B, S, D)),
            "k": _w((lambda *s: torch.randn(*s, dtype=torch.bfloat16) * 0.2)(B, S, D)),
            "v": _w((lambda *s: torch.randn(*s, dtype=torch.bfloat16) * 0.2)(B, S, D)),
            "shift_k": _w((lambda *s: torch.randn(*s, dtype=torch.bfloat16) * 0.2)(D, ks) * 0.5),
            "ssm_k": _w((lambda *s: torch.randn(*s, dtype=torch.bfloat16) * 0.4)(D, S) * (1.0 / S ** 0.5)),
            "ssm_D": _w((lambda *s: torch.randn(*s, dtype=torch.bfloat16) * 0.2)(D)),
        }
    _A_in = _A_setup()

    def _B_setup():
        B, S, D = 1, 2048, 576
        ks = 4
        return {
            "q": _w((lambda *s: torch.randn(*s, dtype=torch.bfloat16) * 0.05)(B, S, D)),
            "k": _w((lambda *s: torch.randn(*s, dtype=torch.bfloat16) * 0.2)(B, S, D)),
            "v": _w((lambda *s: torch.randn(*s, dtype=torch.bfloat16) * 0.2)(B, S, D)),
            "shift_k": _w((lambda *s: torch.randn(*s, dtype=torch.bfloat16) * 0.2)(D, ks) * 0.5),
            "ssm_k": _w((lambda *s: torch.randn(*s, dtype=torch.bfloat16) * 0.4)(D, S) * (1.0 / S ** 0.5)),
            "ssm_D": _w((lambda *s: torch.randn(*s, dtype=torch.bfloat16) * 0.2)(D)),
        }
    _B_in = _B_setup()

    return {
        "A_q": _A_in["q"],
        "A_k": _A_in["k"],
        "A_v": _A_in["v"],
        "A_shift_k": _A_in["shift_k"],
        "A_ssm_k": _A_in["ssm_k"],
        "A_ssm_D": _A_in["ssm_D"],
        "B_q": _B_in["q"],
        "B_k": _B_in["k"],
        "B_v": _B_in["v"],
        "B_shift_k": _B_in["shift_k"],
        "B_ssm_k": _B_in["ssm_k"],
        "B_ssm_D": _B_in["ssm_D"],
    }

def reference(A_q, A_k, A_v, A_shift_k, A_ssm_k, A_ssm_D, B_q, B_k, B_v, B_shift_k, B_ssm_k, B_ssm_D):
    def _A_ref(q, k, v, shift_k, ssm_k, ssm_D):
        B, S, D = q.shape
        ks = shift_k.shape[-1]
        k_pad = _pad(k, ((0, 0), (ks - 1, 0), (0, 0)))
        k_shift = torch.zeros_like(k)
        for t in range(ks):
            k_shift = k_shift + k_pad[:, t:t + S, :] * shift_k[:, ks - 1 - t][None, None, :]
        kv = k_shift * v
        L = 2 * S
        kv_pad = _pad(kv, ((0, 0), (0, S), (0, 0)))
        kf_pad = _pad(ssm_k, ((0, 0), (0, S)))
        kv_f = (lambda x, axes=(-2,-1): torch.fft.rfft2(x.float(), dim=axes))(kv_pad[:, None, :, :], axes=(1, 2))
        kf_f = (lambda x, axes=(-2,-1): torch.fft.rfft2(x.float(), dim=axes))(kf_pad[:, None, :], axes=(1, 2))
        kf_f = (lambda x, *d: x.permute(*d))(kf_f, 1, 2, 0)
        y_f = kv_f * kf_f[None, :, :, :]
        y = (lambda x, s, axes=(-2,-1): torch.fft.irfft2(x, s=s, dim=axes).to(torch.bfloat16))(y_f, (1, L), axes=(1, 2))[:, 0, :S, :]
        y = y + kv * ssm_D[None, None, :]
        return q * y

    def _B_ref(q, k, v, shift_k, ssm_k, ssm_D):
        B, S, D = q.shape
        ks = shift_k.shape[-1]
        k_pad = _pad(k, ((0, 0), (ks - 1, 0), (0, 0)))
        k_shift = torch.zeros_like(k)
        for t in range(ks):
            k_shift = k_shift + k_pad[:, t:t + S, :] * shift_k[:, ks - 1 - t][None, None, :]
        kv = k_shift * v
        L = 2 * S
        kv_pad = _pad(kv, ((0, 0), (0, S), (0, 0)))
        kf_pad = _pad(ssm_k, ((0, 0), (0, S)))
        kv_f = (lambda x, axes=(-2,-1): torch.fft.rfft2(x.float(), dim=axes))(kv_pad[:, None, :, :], axes=(1, 2))
        kf_f = (lambda x, axes=(-2,-1): torch.fft.rfft2(x.float(), dim=axes))(kf_pad[:, None, :], axes=(1, 2))
        kf_f = (lambda x, *d: x.permute(*d))(kf_f, 1, 2, 0)
        y_f = kv_f * kf_f[None, :, :, :]
        y = (lambda x, s, axes=(-2,-1): torch.fft.irfft2(x, s=s, dim=axes).to(torch.bfloat16))(y_f, (1, L), axes=(1, 2))[:, 0, :S, :]
        y = y + kv * ssm_D[None, None, :]
        return q * y

    x = A_q
    x = x + _A_ref(_layernorm(x, axis=-1), A_k, A_v, A_shift_k, A_ssm_k, A_ssm_D)
    x = x + _B_ref(_layernorm(x, axis=-1), B_k, B_v, B_shift_k, B_ssm_k, B_ssm_D)
    x = x + _A_ref(_layernorm(x, axis=-1), A_k, A_v, A_shift_k, A_ssm_k, A_ssm_D)
    x = x + _B_ref(_layernorm(x, axis=-1), B_k, B_v, B_shift_k, B_ssm_k, B_ssm_D)
    return x
```

```asm
; @launch grid=(256,1,1) block=(256,1,1) lds=143680
.amdgcn_target "amdgcn-amd-amdhsa--gfx950"
.text
.globl interleave_layers__ssm_conv_h3__ssm_conv_h3__prompt_kernel
.p2align 8
.type interleave_layers__ssm_conv_h3__ssm_conv_h3__prompt_kernel,@function
interleave_layers__ssm_conv_h3__ssm_conv_h3__prompt_kernel:
    s_cmp_ge_u32 s2, 256
    s_cbranch_scc1 interleave_layers__ssm_conv_h3__ssm_conv_h3__prompt_kernel_end
    s_lshr_b32 s69, s2, 7
    s_mul_i32 s3, s69, 48
    s_add_u32 s22, s0, s3
    s_addc_u32 s23, s1, 0
    s_load_dwordx4 s[4:7], s[22:23], 8
    s_load_dwordx2 s[8:9], s[22:23], 24
    s_and_b32 s60, s2, 7
    s_lshr_b32 s61, s2, 3
    s_lshr_b32 s62, s60, 2
    s_mul_i32 s3, s62, 48
    s_add_u32 s22, s0, s3
    s_addc_u32 s23, s1, 0
    s_load_dwordx2 s[10:11], s[22:23], 32
    s_load_dwordx2 s[12:13], s[22:23], 40
    s_load_dwordx2 s[14:15], s[0:1], 0
    s_load_dwordx4 s[16:19], s[0:1], 96
    s_load_dwordx2 s[20:21], s[0:1], 112
    s_getpc_b64 s[96:97]
cpf_base:
    s_lshr_b32 s3, s2, 3
    s_lshl_b32 s3, s3, 10
    v_and_b32 v12, 7, v0
    v_lshl_add_u32 v12, v12, 7, s3
    v_min_u32 v12, interleave_layers__ssm_conv_h3__ssm_conv_h3__prompt_kernel_end - cpf_base, v12
    v_mov_b32 v13, s97
    v_add_co_u32 v12, vcc, s96, v12
    v_cmp_gt_u32 s[24:25], 8, v0
    s_nop 0
    v_addc_co_u32 v13, vcc, 0, v13, vcc
    s_and_saveexec_b64 s[26:27], s[24:25]
    s_cbranch_execz cpf_skip
    global_load_dword v254, v[12:13], off
cpf_skip:
    s_mov_b64 exec, s[26:27]
no_cpf:
    v_lshrrev_b32 v1, 6, v0
    v_and_b32 v250, 63, v0
    v_readfirstlane_b32 s64, v1
    v_lshlrev_b32 v251, 4, v250
    v_lshlrev_b32 v252, 1, v250
    s_and_b32 s70, s61, 1
    s_bfe_u32 s71, s61, 0x30001
    s_lshl_b32 s3, s60, 3
    s_add_u32 s71, s71, s3
    s_lshl_b32 s79, s69, 7
    s_lshl_b32 s3, s70, 6
    s_add_u32 s79, s79, s3
    s_add_u32 s79, s79, s71
    s_and_b32 s63, s60, 3
    s_lshl_b32 s63, s63, 4
    s_lshr_b32 s3, s61, 1
    s_add_u32 s63, s63, s3
    s_and_b32 s82, s61, 1
    s_lshl_b32 s72, s63, 3
    s_lshl_b32 s3, s82, 2
    s_add_u32 s72, s72, s3
    s_add_u32 s72, s72, s64
    s_add_u32 s73, s63, 512
    s_cmp_eq_u32 s82, 0
    s_mov_b32 s3, 0x6431
    s_cselect_b32 s74, 0x7520, s3
    s_lshl_b32 s3, s64, 2
    s_lshr_b32 s74, s74, s3
    s_and_b32 s74, s74, 7
    s_mul_i32 s75, s64, 16640
    s_mul_i32 s76, s64, 4608
    s_add_u32 s76, s76, 83200
    s_cmp_eq_u32 s64, 3
    s_cbranch_scc1 w3_path
    v_lshrrev_b32 v247, 2, v250
    s_mul_i32 s68, s64, 12
    v_add_u32 v247, s68, v247
    v_and_b32 v248, 3, v250
    s_mul_i32 s66, s70, 32
    s_mul_i32 s67, s70, 4
    s_add_u32 s67, s67, 32
    v_cmp_gt_u32 vcc, 32, v247
    v_add_u32 v249, s67, v247
    v_add_u32 v247, s66, v247
    v_cndmask_b32 v247, v249, v247, vcc
    s_mul_i32 s65, s71, 36864
    v_mul_u32_u24 v242, 9216, v248
    v_lshlrev_b32 v246, 4, v247
    v_add3_u32 v242, v242, v246, s65
    v_add_u32 v243, 4608, v242
    v_subrev_u32 v244, 3456, v242
    v_lshlrev_b32 v248, 4, v248
    v_and_b32 v249, 48, v248
    v_lshl_add_u32 v246, v247, 6, v249
    s_mul_i32 s65, s69, 2433024
    s_add_u32 s65, s65, 4080
    s_mul_i32 s66, s71, 64
    s_sub_u32 s65, s65, s66
    v_mul_u32_u24 v245, 33792, v247
    v_sub_u32 v245, v245, v248
    v_add_u32 v245, s65, v245
    s_waitcnt lgkmcnt(0)
    s_mov_b32 s24, s4
    s_mov_b32 s25, s5
    s_mov_b32 s26, 2359296
    s_mov_b32 s27, 0x00020000
    s_mov_b32 s28, s6
    s_mov_b32 s29, s7
    s_mov_b32 s30, 2359296
    s_mov_b32 s31, 0x00020000
    s_mov_b32 s32, s8
    s_mov_b32 s33, s9
    s_mov_b32 s34, 4608
    s_mov_b32 s35, 0x00020000
    s_mov_b32 exec_hi, 65535
    buffer_load_dwordx4 v[84:87], v246, s[32:35], 0 offen
    buffer_load_dwordx4 v[28:31], v243, s[24:27], 0 offen offset:1152 nt
    buffer_load_dwordx4 v[32:35], v243, s[24:27], 0 offen offset:2304 nt
    buffer_load_dwordx4 v[36:39], v243, s[24:27], 0 offen offset:3456 nt
    s_mov_b32 exec_lo, 286331153
    s_mov_b32 exec_hi, 4369
    buffer_load_dwordx4 v[40:43], v244, s[24:27], 0 offen offset:0 nt
    buffer_load_dwordx4 v[44:47], v244, s[24:27], 0 offen offset:1152 nt
    buffer_load_dwordx4 v[48:51], v244, s[24:27], 0 offen offset:2304 nt
    s_mov_b32 exec_lo, -1
    s_mov_b32 exec_hi, 65535
    buffer_load_dwordx4 v[8:11], v242, s[24:27], 0 offen offset:0 nt
    buffer_load_dwordx4 v[52:55], v242, s[28:31], 0 offen offset:0 nt
    buffer_load_dwordx4 v[12:15], v242, s[24:27], 0 offen offset:1152 nt
    buffer_load_dwordx4 v[56:59], v242, s[28:31], 0 offen offset:1152 nt
    buffer_load_dwordx4 v[16:19], v242, s[24:27], 0 offen offset:2304 nt
    buffer_load_dwordx4 v[60:63], v242, s[28:31], 0 offen offset:2304 nt
    buffer_load_dwordx4 v[20:23], v242, s[24:27], 0 offen offset:3456 nt
    buffer_load_dwordx4 v[64:67], v242, s[28:31], 0 offen offset:3456 nt
    buffer_load_dwordx4 v[24:27], v243, s[24:27], 0 offen offset:0 nt
    buffer_load_dwordx4 v[68:71], v243, s[28:31], 0 offen offset:0 nt
    buffer_load_dwordx4 v[72:75], v243, s[28:31], 0 offen offset:1152 nt
    buffer_load_dwordx4 v[76:79], v243, s[28:31], 0 offen offset:2304 nt
    buffer_load_dwordx4 v[80:83], v243, s[28:31], 0 offen offset:3456 nt
    s_mov_b64 exec, -1
    s_mov_b32 s36, s10
    s_mov_b32 s37, s11
    s_mov_b32 s38, 2359296
    s_mov_b32 s39, 0x00020000
    s_add_u32 s56, s20, 9691136
    s_addc_u32 s57, s21, 0
    s_mov_b32 s58, 327680
    s_mov_b32 s59, 0x00020000
    s_mov_b32 s40, s20
    s_mov_b32 s41, s21
    s_mov_b32 s42, 4866048
    s_mov_b32 s43, 0x00020000
    s_add_u32 s44, s20, 4866048
    s_addc_u32 s45, s21, 0
    s_mov_b32 s46, 4825088
    s_mov_b32 s47, 0x00020000
    s_mov_b32 s52, s16
    s_mov_b32 s53, s17
    s_mov_b32 s54, 2359296
    s_mov_b32 s55, 0x00020000
    s_lshr_b32 s90, s72, 1
    s_lshl_b32 s90, s90, 2
    s_lshr_b32 s91, s73, 1
    s_lshl_b32 s91, s91, 2
    s_load_dword s77, s[12:13], s90
    s_load_dword s78, s[12:13], s91
    v_mov_b32 v253, 163840
    buffer_load_dword v254, v253, s[56:59], 0 offen sc1
    v_and_b32 v1, 15, v250
    v_lshrrev_b32 v2, 4, v250
    v_and_b32 v3, 3, v1
    v_cmp_eq_u32 vcc, 3, v3
    v_mul_u32_u24 v3, 4160, v3
    v_and_b32 v4, 12, v1
    v_lshlrev_b32 v4, 1, v4
    v_add_u32 v3, v3, v4
    v_cndmask_b32 v4, 0, 8, vcc
    v_add_u32 v3, v3, v4
    v_lshl_add_u32 v3, v2, 4, v3
    v_add_u32 v5, s75, v3
    s_lshl_b32 s93, s64, 7
    s_add_u32 s3, s93, 66560
    v_add_u32 v6, s3, v3
    s_mov_b32 vcc_lo, 286331153
    s_mov_b32 vcc_hi, 286331153
    v_mov_b32 v224, 0xffff0000
    s_mov_b32 s4, 4224
    s_mov_b32 s5, 8448
    s_mov_b32 s6, 12672
    s_mov_b32 s7, 16896
    s_mov_b32 s8, 21120
    s_mov_b32 s9, 25344
    s_mov_b32 s10, 29568
p0_body:
    s_waitcnt vmcnt(20)
    v_cvt_f32_bf16_dpp v88, v84 quad_perm:[0,0,0,0] row_mask:0xf bank_mask:0xf
    v_and_b32_dpp v90, v84, v224 quad_perm:[0,0,0,0] row_mask:0xf bank_mask:0xf
    v_cvt_f32_bf16_dpp v92, v85 quad_perm:[0,0,0,0] row_mask:0xf bank_mask:0xf
    v_and_b32_dpp v94, v85, v224 quad_perm:[0,0,0,0] row_mask:0xf bank_mask:0xf
    v_cvt_f32_bf16_dpp v89, v86 quad_perm:[0,0,0,0] row_mask:0xf bank_mask:0xf
    v_and_b32_dpp v91, v86, v224 quad_perm:[0,0,0,0] row_mask:0xf bank_mask:0xf
    v_cvt_f32_bf16_dpp v93, v87 quad_perm:[0,0,0,0] row_mask:0xf bank_mask:0xf
    v_and_b32_dpp v95, v87, v224 quad_perm:[0,0,0,0] row_mask:0xf bank_mask:0xf
    v_cvt_f32_bf16_dpp v96, v84 quad_perm:[1,1,1,1] row_mask:0xf bank_mask:0xf
    v_and_b32_dpp v98, v84, v224 quad_perm:[1,1,1,1] row_mask:0xf bank_mask:0xf
    v_cvt_f32_bf16_dpp v100, v85 quad_perm:[1,1,1,1] row_mask:0xf bank_mask:0xf
    v_and_b32_dpp v102, v85, v224 quad_perm:[1,1,1,1] row_mask:0xf bank_mask:0xf
    v_cvt_f32_bf16_dpp v97, v86 quad_perm:[1,1,1,1] row_mask:0xf bank_mask:0xf
    v_and_b32_dpp v99, v86, v224 quad_perm:[1,1,1,1] row_mask:0xf bank_mask:0xf
    v_cvt_f32_bf16_dpp v101, v87 quad_perm:[1,1,1,1] row_mask:0xf bank_mask:0xf
    v_and_b32_dpp v103, v87, v224 quad_perm:[1,1,1,1] row_mask:0xf bank_mask:0xf
    v_cvt_f32_bf16_dpp v104, v84 quad_perm:[2,2,2,2] row_mask:0xf bank_mask:0xf
    v_and_b32_dpp v106, v84, v224 quad_perm:[2,2,2,2] row_mask:0xf bank_mask:0xf
    v_cvt_f32_bf16_dpp v108, v85 quad_perm:[2,2,2,2] row_mask:0xf bank_mask:0xf
    v_and_b32_dpp v110, v85, v224 quad_perm:[2,2,2,2] row_mask:0xf bank_mask:0xf
    v_cvt_f32_bf16_dpp v105, v86 quad_perm:[2,2,2,2] row_mask:0xf bank_mask:0xf
    v_and_b32_dpp v107, v86, v224 quad_perm:[2,2,2,2] row_mask:0xf bank_mask:0xf
    v_cvt_f32_bf16_dpp v109, v87 quad_perm:[2,2,2,2] row_mask:0xf bank_mask:0xf
    v_and_b32_dpp v111, v87, v224 quad_perm:[2,2,2,2] row_mask:0xf bank_mask:0xf
    v_cvt_f32_bf16_dpp v112, v84 quad_perm:[3,3,3,3] row_mask:0xf bank_mask:0xf
    v_and_b32_dpp v114, v84, v224 quad_perm:[3,3,3,3] row_mask:0xf bank_mask:0xf
    v_cvt_f32_bf16_dpp v116, v85 quad_perm:[3,3,3,3] row_mask:0xf bank_mask:0xf
    v_and_b32_dpp v118, v85, v224 quad_perm:[3,3,3,3] row_mask:0xf bank_mask:0xf
    v_cvt_f32_bf16_dpp v113, v86 quad_perm:[3,3,3,3] row_mask:0xf bank_mask:0xf
    v_and_b32_dpp v115, v86, v224 quad_perm:[3,3,3,3] row_mask:0xf bank_mask:0xf
    v_cvt_f32_bf16_dpp v117, v87 quad_perm:[3,3,3,3] row_mask:0xf bank_mask:0xf
    v_and_b32_dpp v119, v87, v224 quad_perm:[3,3,3,3] row_mask:0xf bank_mask:0xf
    s_waitcnt vmcnt(16)
    v_cndmask_b32_dpp v40, v28, v40, vcc quad_perm:[0,0,1,2] row_mask:0xf bank_mask:0xf
    v_cndmask_b32_dpp v41, v29, v41, vcc quad_perm:[0,0,1,2] row_mask:0xf bank_mask:0xf
    v_cndmask_b32_dpp v42, v30, v42, vcc quad_perm:[0,0,1,2] row_mask:0xf bank_mask:0xf
    v_cndmask_b32_dpp v43, v31, v43, vcc quad_perm:[0,0,1,2] row_mask:0xf bank_mask:0xf
    v_lshlrev_b32 v120, 16, v40
    v_and_b32 v121, 0xffff0000, v40
    v_lshlrev_b32 v122, 16, v41
    v_and_b32 v123, 0xffff0000, v41
    v_lshlrev_b32 v124, 16, v42
    v_and_b32 v125, 0xffff0000, v42
    v_lshlrev_b32 v126, 16, v43
    v_and_b32 v127, 0xffff0000, v43
    s_waitcnt vmcnt(15)
    v_cndmask_b32_dpp v44, v32, v44, vcc quad_perm:[0,0,1,2] row_mask:0xf bank_mask:0xf
    v_cndmask_b32_dpp v45, v33, v45, vcc quad_perm:[0,0,1,2] row_mask:0xf bank_mask:0xf
    v_cndmask_b32_dpp v46, v34, v46, vcc quad_perm:[0,0,1,2] row_mask:0xf bank_mask:0xf
    v_cndmask_b32_dpp v47, v35, v47, vcc quad_perm:[0,0,1,2] row_mask:0xf bank_mask:0xf
    v_lshlrev_b32 v128, 16, v44
    v_and_b32 v129, 0xffff0000, v44
    v_lshlrev_b32 v130, 16, v45
    v_and_b32 v131, 0xffff0000, v45
    v_lshlrev_b32 v132, 16, v46
    v_and_b32 v133, 0xffff0000, v46
    v_lshlrev_b32 v134, 16, v47
    v_and_b32 v135, 0xffff0000, v47
    s_waitcnt vmcnt(14)
    v_cndmask_b32_dpp v48, v36, v48, vcc quad_perm:[0,0,1,2] row_mask:0xf bank_mask:0xf
    v_cndmask_b32_dpp v49, v37, v49, vcc quad_perm:[0,0,1,2] row_mask:0xf bank_mask:0xf
    v_cndmask_b32_dpp v50, v38, v50, vcc quad_perm:[0,0,1,2] row_mask:0xf bank_mask:0xf
    v_cndmask_b32_dpp v51, v39, v51, vcc quad_perm:[0,0,1,2] row_mask:0xf bank_mask:0xf
    v_lshlrev_b32 v136, 16, v48
    v_and_b32 v137, 0xffff0000, v48
    v_lshlrev_b32 v138, 16, v49
    v_and_b32 v139, 0xffff0000, v49
    v_lshlrev_b32 v140, 16, v50
    v_and_b32 v141, 0xffff0000, v50
    v_lshlrev_b32 v142, 16, v51
    v_and_b32 v143, 0xffff0000, v51
    s_waitcnt vmcnt(13)
    v_lshlrev_b32 v144, 16, v8
    v_and_b32 v145, 0xffff0000, v8
    v_lshlrev_b32 v146, 16, v9
    v_and_b32 v147, 0xffff0000, v9
    v_lshlrev_b32 v148, 16, v10
    v_and_b32 v149, 0xffff0000, v10
    v_lshlrev_b32 v150, 16, v11
    v_and_b32 v151, 0xffff0000, v11
    v_pk_mul_f32 v[184:185], v[120:121], v[94:95]
    v_pk_mul_f32 v[186:187], v[122:123], v[102:103]
    v_pk_mul_f32 v[188:189], v[124:125], v[110:111]
    v_pk_mul_f32 v[190:191], v[126:127], v[118:119]
    v_pk_fma_f32 v[184:185], v[128:129], v[92:93], v[184:185]
    v_pk_fma_f32 v[186:187], v[130:131], v[100:101], v[186:187]
    v_pk_fma_f32 v[188:189], v[132:133], v[108:109], v[188:189]
    v_pk_fma_f32 v[190:191], v[134:135], v[116:117], v[190:191]
    v_pk_fma_f32 v[184:185], v[136:137], v[90:91], v[184:185]
    v_pk_fma_f32 v[186:187], v[138:139], v[98:99], v[186:187]
    v_pk_fma_f32 v[188:189], v[140:141], v[106:107], v[188:189]
    v_pk_fma_f32 v[190:191], v[142:143], v[114:115], v[190:191]
    v_pk_fma_f32 v[184:185], v[144:145], v[88:89], v[184:185]
    v_pk_fma_f32 v[186:187], v[146:147], v[96:97], v[186:187]
    v_pk_fma_f32 v[188:189], v[148:149], v[104:105], v[188:189]
    v_pk_fma_f32 v[190:191], v[150:151], v[112:113], v[190:191]
    v_lshlrev_b32 v120, 16, v28
    v_and_b32 v121, 0xffff0000, v28
    v_lshlrev_b32 v122, 16, v29
    v_and_b32 v123, 0xffff0000, v29
    v_lshlrev_b32 v124, 16, v30
    v_and_b32 v125, 0xffff0000, v30
    v_lshlrev_b32 v126, 16, v31
    v_and_b32 v127, 0xffff0000, v31
    s_waitcnt vmcnt(12)
    v_lshlrev_b32 v216, 16, v52
    v_and_b32 v217, 0xffff0000, v52
    v_lshlrev_b32 v218, 16, v53
    v_and_b32 v219, 0xffff0000, v53
    v_lshlrev_b32 v220, 16, v54
    v_and_b32 v221, 0xffff0000, v54
    v_lshlrev_b32 v222, 16, v55
    v_and_b32 v223, 0xffff0000, v55
    v_pk_mul_f32 v[184:185], v[184:185], v[216:217]
    v_pk_mul_f32 v[186:187], v[186:187], v[218:219]
    v_pk_mul_f32 v[188:189], v[188:189], v[220:221]
    v_pk_mul_f32 v[190:191], v[190:191], v[222:223]
    s_waitcnt vmcnt(11)
    v_lshlrev_b32 v152, 16, v12
    v_and_b32 v153, 0xffff0000, v12
    v_lshlrev_b32 v154, 16, v13
    v_and_b32 v155, 0xffff0000, v13
    v_lshlrev_b32 v156, 16, v14
    v_and_b32 v157, 0xffff0000, v14
    v_lshlrev_b32 v158, 16, v15
    v_and_b32 v159, 0xffff0000, v15
    v_pk_mul_f32 v[192:193], v[128:129], v[94:95]
    v_pk_mul_f32 v[194:195], v[130:131], v[102:103]
    v_pk_mul_f32 v[196:197], v[132:133], v[110:111]
    v_pk_mul_f32 v[198:199], v[134:135], v[118:119]
    v_pk_fma_f32 v[192:193], v[136:137], v[92:93], v[192:193]
    v_pk_fma_f32 v[194:195], v[138:139], v[100:101], v[194:195]
    v_pk_fma_f32 v[196:197], v[140:141], v[108:109], v[196:197]
    v_pk_fma_f32 v[198:199], v[142:143], v[116:117], v[198:199]
    v_pk_fma_f32 v[192:193], v[144:145], v[90:91], v[192:193]
    v_pk_fma_f32 v[194:195], v[146:147], v[98:99], v[194:195]
    v_pk_fma_f32 v[196:197], v[148:149], v[106:107], v[196:197]
    v_pk_fma_f32 v[198:199], v[150:151], v[114:115], v[198:199]
    v_pk_fma_f32 v[192:193], v[152:153], v[88:89], v[192:193]
    v_pk_fma_f32 v[194:195], v[154:155], v[96:97], v[194:195]
    v_pk_fma_f32 v[196:197], v[156:157], v[104:105], v[196:197]
    v_pk_fma_f32 v[198:199], v[158:159], v[112:113], v[198:199]
    v_lshlrev_b32 v128, 16, v32
    v_and_b32 v129, 0xffff0000, v32
    v_lshlrev_b32 v130, 16, v33
    v_and_b32 v131, 0xffff0000, v33
    v_lshlrev_b32 v132, 16, v34
    v_and_b32 v133, 0xffff0000, v34
    v_lshlrev_b32 v134, 16, v35
    v_and_b32 v135, 0xffff0000, v35
    s_waitcnt vmcnt(10)
    v_lshlrev_b32 v216, 16, v56
    v_and_b32 v217, 0xffff0000, v56
    v_lshlrev_b32 v218, 16, v57
    v_and_b32 v219, 0xffff0000, v57
    v_lshlrev_b32 v220, 16, v58
    v_and_b32 v221, 0xffff0000, v58
    v_lshlrev_b32 v222, 16, v59
    v_and_b32 v223, 0xffff0000, v59
    v_pk_mul_f32 v[192:193], v[192:193], v[216:217]
    v_pk_mul_f32 v[194:195], v[194:195], v[218:219]
    v_pk_mul_f32 v[196:197], v[196:197], v[220:221]
    v_pk_mul_f32 v[198:199], v[198:199], v[222:223]
    v_cvt_pk_bf16_f32 v43, v192, v184
    v_cvt_pk_bf16_f32 v47, v193, v185
    v_cvt_pk_bf16_f32 v51, v194, v186
    v_cvt_pk_bf16_f32 v11, v195, v187
    v_cvt_pk_bf16_f32 v15, v196, v188
    v_cvt_pk_bf16_f32 v55, v197, v189
    v_cvt_pk_bf16_f32 v59, v198, v190
    v_cvt_pk_bf16_f32 v87, v199, v191
    s_waitcnt vmcnt(9)
    v_lshlrev_b32 v160, 16, v16
    v_and_b32 v161, 0xffff0000, v16
    v_lshlrev_b32 v162, 16, v17
    v_and_b32 v163, 0xffff0000, v17
    v_lshlrev_b32 v164, 16, v18
    v_and_b32 v165, 0xffff0000, v18
    v_lshlrev_b32 v166, 16, v19
    v_and_b32 v167, 0xffff0000, v19
    v_pk_mul_f32 v[200:201], v[136:137], v[94:95]
    v_pk_mul_f32 v[202:203], v[138:139], v[102:103]
    v_pk_mul_f32 v[204:205], v[140:141], v[110:111]
    v_pk_mul_f32 v[206:207], v[142:143], v[118:119]
    v_pk_fma_f32 v[200:201], v[144:145], v[92:93], v[200:201]
    v_pk_fma_f32 v[202:203], v[146:147], v[100:101], v[202:203]
    v_pk_fma_f32 v[204:205], v[148:149], v[108:109], v[204:205]
    v_pk_fma_f32 v[206:207], v[150:151], v[116:117], v[206:207]
    v_pk_fma_f32 v[200:201], v[152:153], v[90:91], v[200:201]
    v_pk_fma_f32 v[202:203], v[154:155], v[98:99], v[202:203]
    v_pk_fma_f32 v[204:205], v[156:157], v[106:107], v[204:205]
    v_pk_fma_f32 v[206:207], v[158:159], v[114:115], v[206:207]
    v_pk_fma_f32 v[200:201], v[160:161], v[88:89], v[200:201]
    v_pk_fma_f32 v[202:203], v[162:163], v[96:97], v[202:203]
    v_pk_fma_f32 v[204:205], v[164:165], v[104:105], v[204:205]
    v_pk_fma_f32 v[206:207], v[166:167], v[112:113], v[206:207]
    v_lshlrev_b32 v136, 16, v36
    v_and_b32 v137, 0xffff0000, v36
    v_lshlrev_b32 v138, 16, v37
    v_and_b32 v139, 0xffff0000, v37
    v_lshlrev_b32 v140, 16, v38
    v_and_b32 v141, 0xffff0000, v38
    v_lshlrev_b32 v142, 16, v39
    v_and_b32 v143, 0xffff0000, v39
    s_waitcnt vmcnt(8)
    v_lshlrev_b32 v216, 16, v60
    v_and_b32 v217, 0xffff0000, v60
    v_lshlrev_b32 v218, 16, v61
    v_and_b32 v219, 0xffff0000, v61
    v_lshlrev_b32 v220, 16, v62
    v_and_b32 v221, 0xffff0000, v62
    v_lshlrev_b32 v222, 16, v63
    v_and_b32 v223, 0xffff0000, v63
    v_pk_mul_f32 v[200:201], v[200:201], v[216:217]
    v_pk_mul_f32 v[202:203], v[202:203], v[218:219]
    v_pk_mul_f32 v[204:205], v[204:205], v[220:221]
    v_pk_mul_f32 v[206:207], v[206:207], v[222:223]
    s_waitcnt vmcnt(7)
    v_lshlrev_b32 v168, 16, v20
    v_and_b32 v169, 0xffff0000, v20
    v_lshlrev_b32 v170, 16, v21
    v_and_b32 v171, 0xffff0000, v21
    v_lshlrev_b32 v172, 16, v22
    v_and_b32 v173, 0xffff0000, v22
    v_lshlrev_b32 v174, 16, v23
    v_and_b32 v175, 0xffff0000, v23
    v_pk_mul_f32 v[208:209], v[144:145], v[94:95]
    v_pk_mul_f32 v[210:211], v[146:147], v[102:103]
    v_pk_mul_f32 v[212:213], v[148:149], v[110:111]
    v_pk_mul_f32 v[214:215], v[150:151], v[118:119]
    v_pk_fma_f32 v[208:209], v[152:153], v[92:93], v[208:209]
    v_pk_fma_f32 v[210:211], v[154:155], v[100:101], v[210:211]
    v_pk_fma_f32 v[212:213], v[156:157], v[108:109], v[212:213]
    v_pk_fma_f32 v[214:215], v[158:159], v[116:117], v[214:215]
    v_pk_fma_f32 v[208:209], v[160:161], v[90:91], v[208:209]
    v_pk_fma_f32 v[210:211], v[162:163], v[98:99], v[210:211]
    v_pk_fma_f32 v[212:213], v[164:165], v[106:107], v[212:213]
    v_pk_fma_f32 v[214:215], v[166:167], v[114:115], v[214:215]
    v_pk_fma_f32 v[208:209], v[168:169], v[88:89], v[208:209]
    v_pk_fma_f32 v[210:211], v[170:171], v[96:97], v[210:211]
    v_pk_fma_f32 v[212:213], v[172:173], v[104:105], v[212:213]
    v_pk_fma_f32 v[214:215], v[174:175], v[112:113], v[214:215]
    s_waitcnt vmcnt(6)
    v_lshlrev_b32 v216, 16, v64
    v_and_b32 v217, 0xffff0000, v64
    v_lshlrev_b32 v218, 16, v65
    v_and_b32 v219, 0xffff0000, v65
    v_lshlrev_b32 v220, 16, v66
    v_and_b32 v221, 0xffff0000, v66
    v_lshlrev_b32 v222, 16, v67
    v_and_b32 v223, 0xffff0000, v67
    v_pk_mul_f32 v[208:209], v[208:209], v[216:217]
    v_pk_mul_f32 v[210:211], v[210:211], v[218:219]
    v_pk_mul_f32 v[212:213], v[212:213], v[220:221]
    v_pk_mul_f32 v[214:215], v[214:215], v[222:223]
    v_cvt_pk_bf16_f32 v42, v208, v200
    v_cvt_pk_bf16_f32 v46, v209, v201
    v_cvt_pk_bf16_f32 v50, v210, v202
    v_cvt_pk_bf16_f32 v10, v211, v203
    v_cvt_pk_bf16_f32 v14, v212, v204
    v_cvt_pk_bf16_f32 v54, v213, v205
    v_cvt_pk_bf16_f32 v58, v214, v206
    v_cvt_pk_bf16_f32 v86, v215, v207
    s_waitcnt vmcnt(5)
    v_lshlrev_b32 v176, 16, v24
    v_and_b32 v177, 0xffff0000, v24
    v_lshlrev_b32 v178, 16, v25
    v_and_b32 v179, 0xffff0000, v25
    v_lshlrev_b32 v180, 16, v26
    v_and_b32 v181, 0xffff0000, v26
    v_lshlrev_b32 v182, 16, v27
    v_and_b32 v183, 0xffff0000, v27
    v_pk_mul_f32 v[184:185], v[152:153], v[94:95]
    v_pk_mul_f32 v[186:187], v[154:155], v[102:103]
    v_pk_mul_f32 v[188:189], v[156:157], v[110:111]
    v_pk_mul_f32 v[190:191], v[158:159], v[118:119]
    v_pk_fma_f32 v[184:185], v[160:161], v[92:93], v[184:185]
    v_pk_fma_f32 v[186:187], v[162:163], v[100:101], v[186:187]
    v_pk_fma_f32 v[188:189], v[164:165], v[108:109], v[188:189]
    v_pk_fma_f32 v[190:191], v[166:167], v[116:117], v[190:191]
    v_pk_fma_f32 v[184:185], v[168:169], v[90:91], v[184:185]
    v_pk_fma_f32 v[186:187], v[170:171], v[98:99], v[186:187]
    v_pk_fma_f32 v[188:189], v[172:173], v[106:107], v[188:189]
    v_pk_fma_f32 v[190:191], v[174:175], v[114:115], v[190:191]
    v_pk_fma_f32 v[184:185], v[176:177], v[88:89], v[184:185]
    v_pk_fma_f32 v[186:187], v[178:179], v[96:97], v[186:187]
    v_pk_fma_f32 v[188:189], v[180:181], v[104:105], v[188:189]
    v_pk_fma_f32 v[190:191], v[182:183], v[112:113], v[190:191]
    v_pk_mul_f32 v[192:193], v[160:161], v[94:95]
    v_pk_mul_f32 v[194:195], v[162:163], v[102:103]
    v_pk_mul_f32 v[196:197], v[164:165], v[110:111]
    v_pk_mul_f32 v[198:199], v[166:167], v[118:119]
    v_pk_fma_f32 v[192:193], v[168:169], v[92:93], v[192:193]
    v_pk_fma_f32 v[194:195], v[170:171], v[100:101], v[194:195]
    v_pk_fma_f32 v[196:197], v[172:173], v[108:109], v[196:197]
    v_pk_fma_f32 v[198:199], v[174:175], v[116:117], v[198:199]
    v_pk_fma_f32 v[192:193], v[176:177], v[90:91], v[192:193]
    v_pk_fma_f32 v[194:195], v[178:179], v[98:99], v[194:195]
    v_pk_fma_f32 v[196:197], v[180:181], v[106:107], v[196:197]
    v_pk_fma_f32 v[198:199], v[182:183], v[114:115], v[198:199]
    v_pk_fma_f32 v[192:193], v[120:121], v[88:89], v[192:193]
    v_pk_fma_f32 v[194:195], v[122:123], v[96:97], v[194:195]
    v_pk_fma_f32 v[196:197], v[124:125], v[104:105], v[196:197]
    v_pk_fma_f32 v[198:199], v[126:127], v[112:113], v[198:199]
    v_pk_mul_f32 v[200:201], v[168:169], v[94:95]
    v_pk_mul_f32 v[202:203], v[170:171], v[102:103]
    v_pk_mul_f32 v[204:205], v[172:173], v[110:111]
    v_pk_mul_f32 v[206:207], v[174:175], v[118:119]
    v_pk_fma_f32 v[200:201], v[176:177], v[92:93], v[200:201]
    v_pk_fma_f32 v[202:203], v[178:179], v[100:101], v[202:203]
    v_pk_fma_f32 v[204:205], v[180:181], v[108:109], v[204:205]
    v_pk_fma_f32 v[206:207], v[182:183], v[116:117], v[206:207]
    v_pk_fma_f32 v[200:201], v[120:121], v[90:91], v[200:201]
    v_pk_fma_f32 v[202:203], v[122:123], v[98:99], v[202:203]
    v_pk_fma_f32 v[204:205], v[124:125], v[106:107], v[204:205]
    v_pk_fma_f32 v[206:207], v[126:127], v[114:115], v[206:207]
    v_pk_fma_f32 v[200:201], v[128:129], v[88:89], v[200:201]
    v_pk_fma_f32 v[202:203], v[130:131], v[96:97], v[202:203]
    v_pk_fma_f32 v[204:205], v[132:133], v[104:105], v[204:205]
    v_pk_fma_f32 v[206:207], v[134:135], v[112:113], v[206:207]
    v_pk_mul_f32 v[208:209], v[176:177], v[94:95]
    v_pk_mul_f32 v[210:211], v[178:179], v[102:103]
    v_pk_mul_f32 v[212:213], v[180:181], v[110:111]
    v_pk_mul_f32 v[214:215], v[182:183], v[118:119]
    v_pk_fma_f32 v[208:209], v[120:121], v[92:93], v[208:209]
    v_pk_fma_f32 v[210:211], v[122:123], v[100:101], v[210:211]
    v_pk_fma_f32 v[212:213], v[124:125], v[108:109], v[212:213]
    v_pk_fma_f32 v[214:215], v[126:127], v[116:117], v[214:215]
    v_pk_fma_f32 v[208:209], v[128:129], v[90:91], v[208:209]
    v_pk_fma_f32 v[210:211], v[130:131], v[98:99], v[210:211]
    v_pk_fma_f32 v[212:213], v[132:133], v[106:107], v[212:213]
    v_pk_fma_f32 v[214:215], v[134:135], v[114:115], v[214:215]
    v_pk_fma_f32 v[208:209], v[136:137], v[88:89], v[208:209]
    v_pk_fma_f32 v[210:211], v[138:139], v[96:97], v[210:211]
    v_pk_fma_f32 v[212:213], v[140:141], v[104:105], v[212:213]
    v_pk_fma_f32 v[214:215], v[142:143], v[112:113], v[214:215]
    s_waitcnt vmcnt(4)
    v_lshlrev_b32 v216, 16, v68
    v_and_b32 v217, 0xffff0000, v68
    v_lshlrev_b32 v218, 16, v69
    v_and_b32 v219, 0xffff0000, v69
    v_lshlrev_b32 v220, 16, v70
    v_and_b32 v221, 0xffff0000, v70
    v_lshlrev_b32 v222, 16, v71
    v_and_b32 v223, 0xffff0000, v71
    v_pk_mul_f32 v[184:185], v[184:185], v[216:217]
    v_pk_mul_f32 v[186:187], v[186:187], v[218:219]
    v_pk_mul_f32 v[188:189], v[188:189], v[220:221]
    v_pk_mul_f32 v[190:191], v[190:191], v[222:223]
    s_waitcnt vmcnt(3)
    v_lshlrev_b32 v216, 16, v72
    v_and_b32 v217, 0xffff0000, v72
    v_lshlrev_b32 v218, 16, v73
    v_and_b32 v219, 0xffff0000, v73
    v_lshlrev_b32 v220, 16, v74
    v_and_b32 v221, 0xffff0000, v74
    v_lshlrev_b32 v222, 16, v75
    v_and_b32 v223, 0xffff0000, v75
    v_pk_mul_f32 v[192:193], v[192:193], v[216:217]
    v_pk_mul_f32 v[194:195], v[194:195], v[218:219]
    v_pk_mul_f32 v[196:197], v[196:197], v[220:221]
    v_pk_mul_f32 v[198:199], v[198:199], v[222:223]
    v_cvt_pk_bf16_f32 v41, v192, v184
    v_cvt_pk_bf16_f32 v45, v193, v185
    v_cvt_pk_bf16_f32 v49, v194, v186
    v_cvt_pk_bf16_f32 v9, v195, v187
    v_cvt_pk_bf16_f32 v13, v196, v188
    v_cvt_pk_bf16_f32 v53, v197, v189
    v_cvt_pk_bf16_f32 v57, v198, v190
    v_cvt_pk_bf16_f32 v85, v199, v191
    s_waitcnt vmcnt(2)
    v_lshlrev_b32 v216, 16, v76
    v_and_b32 v217, 0xffff0000, v76
    v_lshlrev_b32 v218, 16, v77
    v_and_b32 v219, 0xffff0000, v77
    v_lshlrev_b32 v220, 16, v78
    v_and_b32 v221, 0xffff0000, v78
    v_lshlrev_b32 v222, 16, v79
    v_and_b32 v223, 0xffff0000, v79
    v_pk_mul_f32 v[200:201], v[200:201], v[216:217]
    v_pk_mul_f32 v[202:203], v[202:203], v[218:219]
    v_pk_mul_f32 v[204:205], v[204:205], v[220:221]
    v_pk_mul_f32 v[206:207], v[206:207], v[222:223]
    s_waitcnt vmcnt(1)
    v_lshlrev_b32 v216, 16, v80
    v_and_b32 v217, 0xffff0000, v80
    v_lshlrev_b32 v218, 16, v81
    v_and_b32 v219, 0xffff0000, v81
    v_lshlrev_b32 v220, 16, v82
    v_and_b32 v221, 0xffff0000, v82
    v_lshlrev_b32 v222, 16, v83
    v_and_b32 v223, 0xffff0000, v83
    v_pk_mul_f32 v[208:209], v[208:209], v[216:217]
    v_pk_mul_f32 v[210:211], v[210:211], v[218:219]
    v_pk_mul_f32 v[212:213], v[212:213], v[220:221]
    v_pk_mul_f32 v[214:215], v[214:215], v[222:223]
    s_mov_b32 exec_hi, 65535
    v_cvt_pk_bf16_f32 v40, v208, v200
    buffer_store_dwordx4 v[40:43], v245, s[40:43], 0 offen sc1
    v_cvt_pk_bf16_f32 v44, v209, v201
    buffer_store_dwordx4 v[44:47], v245, s[40:43], s4 offen sc1
    v_cvt_pk_bf16_f32 v48, v210, v202
    buffer_store_dwordx4 v[48:51], v245, s[40:43], s5 offen sc1
    v_cvt_pk_bf16_f32 v8, v211, v203
    buffer_store_dwordx4 v[8:11], v245, s[40:43], s6 offen sc1
    v_cvt_pk_bf16_f32 v12, v212, v204
    buffer_store_dwordx4 v[12:15], v245, s[40:43], s7 offen sc1
    v_cvt_pk_bf16_f32 v52, v213, v205
    buffer_store_dwordx4 v[52:55], v245, s[40:43], s8 offen sc1
    v_cvt_pk_bf16_f32 v56, v214, v206
    buffer_store_dwordx4 v[56:59], v245, s[40:43], s9 offen sc1
    v_cvt_pk_bf16_f32 v84, v215, v207
    buffer_store_dwordx4 v[84:87], v245, s[40:43], s10 offen sc1
    s_mov_b64 exec, -1
    s_lshl_b32 s3, s72, 12
    s_add_u32 s92, s75, 12512
    s_mov_b32 m0, s92
    s_nop 0
    buffer_load_dwordx4 v251, s[36:39], s3 offen offset:0  lds
    buffer_load_dwordx4 v251, s[36:39], s3 offen offset:1024  lds
    buffer_load_dwordx4 v251, s[36:39], s3 offen offset:2048  lds
    buffer_load_dwordx4 v251, s[36:39], s3 offen offset:3072  lds
    s_lshl_b32 s3, s73, 12
    s_lshl_b32 s92, s64, 10
    s_add_u32 s3, s3, s92
    s_add_u32 s92, s92, 79072
    s_mov_b32 m0, s92
    s_nop 0
    buffer_load_dwordx4 v251, s[36:39], s3 offen  lds
    s_barrier
    v_mov_b32 v180, 0
    v_mov_b32 v181, 0
    v_mov_b32 v182, 0
    v_mov_b32 v183, 0
    v_add_u32 v176, s75, v251
    v_mov_b32 v177, s75
    v_mov_b32 v179, 66560
    s_waitcnt vmcnt(13)
    v_readfirstlane_b32 s83, v254
    s_mul_i32 s83, s83, 0x9E3779B1
    s_add_u32 s83, s83, 0x7F4A7C15
    s_waitcnt lgkmcnt(0)
    v_add_u32 v8, s76, v251
    s_add_u32 s3, s93, 101120
    v_add_u32 v9, s3, v251
    v_cmp_gt_u32 vcc, 32, v250
    s_mov_b32 exec_hi, 0xff
    s_nop 0
    v_cndmask_b32 v8, v9, v8, vcc
    ds_write_b128 v8, v[180:183] offset:4096
    s_mov_b64 exec, -1
    s_and_b32 s3, s72, 1
    s_lshl_b32 s3, s3, 4
    s_lshr_b32 s77, s77, s3
    s_and_b32 s77, s77, 0xffff
    s_and_b32 s3, s73, 1
    s_lshl_b32 s3, s3, 4
    s_lshr_b32 s78, s78, s3
    s_and_b32 s78, s78, 0xffff
    s_lshl_b32 s78, s78, 16
    v_lshlrev_b32 v3, 3, v2
    v_add_u32 v3, v3, v1
    v_sub_u32 v3, 15, v3
    v_and_b32 v4, 1, v3
    v_lshlrev_b32 v4, 4, v4
    v_ashrrev_i32 v3, 1, v3
    v_lshlrev_b32 v8, v4, s77
    v_cmp_eq_u32 vcc, 0, v3
    s_nop 1
    v_cndmask_b32 v216, 0, v8, vcc
    v_cmp_eq_u32 vcc, 1, v3
    s_nop 1
    v_cndmask_b32 v217, 0, v8, vcc
    v_cmp_eq_u32 vcc, 2, v3
    s_nop 1
    v_cndmask_b32 v218, 0, v8, vcc
    v_cmp_eq_u32 vcc, 3, v3
    s_nop 1
    v_cndmask_b32 v219, 0, v8, vcc
    v_lshlrev_b32 v3, 4, v2
    v_lshlrev_b32 v4, 5, v1
    v_sub_u32 v3, v3, v4
    v_add_u32 v3, 480, v3
    v_add_u32 v7, s76, v3
    s_add_u32 s3, s93, 101632
    v_add_u32 v226, s3, v3
    v_lshlrev_b32 v3, 3, v2
    v_add_u32 v3, v3, v4
    s_lshl_b32 s3, s74, 9
    s_sub_u32 s3, 105720, s3
    v_sub_u32 v231, s3, v3
    s_lshl_b32 s3, s64, 9
    s_add_u32 s3, s3, 124736
    v_add_u32 v227, s3, v3
    v_add_u32 v228, s3, v251
    s_lshl_b32 s3, s64, 10
    s_add_u32 s3, s3, 127296
    v_add_u32 v229, s3, v251
    s_lshl_b32 s3, s64, 12
    s_add_u32 s3, s3, 127296
    v_add_u32 v230, s3, v251
    v_mul_u32_u24 v224, 144, v1
    v_lshrrev_b32 v3, 1, v2
    v_lshl_add_u32 v224, v3, 6, v224
    v_and_b32 v3, 1, v2
    v_lshl_add_u32 v224, v3, 3, v224
    s_lshl_b32 s3, s64, 4
    s_add_u32 s3, s3, 106304
    v_add_u32 v224, s3, v224
    v_lshrrev_b32 v3, 3, v250
    v_mul_u32_u24 v225, 144, v3
    v_and_b32 v4, 7, v250
    v_lshl_add_u32 v225, v4, 4, v225
    s_mul_i32 s3, s64, 1152
    s_add_u32 s3, s3, 106304
    v_add_u32 v225, s3, v225
    v_mul_u32_u24 v234, 1028, v4
    v_lshl_add_u32 v234, v3, 4, v234
    s_lshr_b32 s88, s64, 1
    s_mul_i32 s89, s88, 9264
    s_and_b32 s3, s64, 1
    s_lshl_b32 s3, s3, 9
    s_add_u32 s89, s89, s3
    s_add_u32 s89, s89, 0
    v_add_u32 v234, s89, v234
    s_add_u32 s89, s89, 8224
    v_and_b32 v8, 3, v3
    v_lshl_add_u32 v235, v8, 2, v251
    v_xor_b32 v8, s64, v8
    v_lshl_add_u32 v237, v8, 2, v251
    s_mov_b32 s98, s89
    v_lshlrev_b32 v236, 6, v250
    s_mul_i32 s88, s2, 16768
    s_lshl_b32 s3, s64, 12
    s_add_u32 s88, s88, s3
    s_lshr_b32 s89, s2, 2
    s_mul_i32 s89, s89, 8320
    s_mov_b32 s99, s89
    s_lshl_b32 s3, s64, 11
    s_add_u32 s89, s89, s3
    s_and_b32 s3, s2, 3
    s_lshl_b32 s3, s3, 4
    s_add_u32 s89, s89, s3
    s_add_u32 s89, s89, 4292608
    v_lshrrev_b32 v4, 2, v250
    v_and_b32 v8, 3, v250
    v_lshlrev_b32 v8, 4, v8
    v_mul_u32_u24 v3, 16768, v4
    v_add_u32 v3, v3, v8
    v_mul_u32_u24 v4, 8320, v4
    v_add_u32 v4, v4, v8
    s_mul_i32 s80, s64, 268288
    s_lshl_b32 s3, s62, 13
    s_add_u32 s80, s80, s3
    s_sub_u32 s3, s72, s64
    s_lshl_b32 s3, s3, 4
    s_add_u32 s80, s80, s3
    s_mul_i32 s81, s74, 66560
    s_lshl_b32 s3, s62, 12
    s_add_u32 s81, s81, s3
    s_lshl_b32 s3, s63, 6
    s_add_u32 s81, s81, s3
    s_add_u32 s81, s81, 4292608
    s_mov_b32 s48, s14
    s_mov_b32 s49, s15
    s_mov_b32 s50, 2359296
    s_mov_b32 s51, 0x00020000
    s_lshl_b32 s84, s2, 3
    s_lshl_b32 s3, s64, 1
    s_add_u32 s84, s84, s3
    s_mul_i32 s84, s84, 1152
    s_mul_i32 s3, s62, 576
    s_add_u32 s90, s3, s72
    s_mul_i32 s90, s90, 4224
    s_add_u32 s91, s3, s73
    s_mul_i32 s91, s91, 4224
    s_lshl_b32 s85, s64, 10
    s_add_u32 s91, s91, s85
    s_add_u32 s85, s85, 101632
    s_lshl_b32 s92, s62, 1
    s_lshr_b32 s3, s63, 5
    s_add_u32 s92, s92, s3
    s_lshl_b32 s92, s92, 2
    s_add_u32 s92, s92, s64
    s_lshl_b32 s92, s92, 11
    v_and_b32 v8, 15, v1
    v_lshl_add_u32 v232, v8, 7, s92
    s_lshl_b32 s92, s64, 13
    s_add_u32 s92, s92, 131072
    v_lshl_add_u32 v233, v250, 7, s92
    v_add_u32 v176, s75, v251
    v_mov_b32 v177, s75
    s_lshl_b32 s3, s64, 10
    s_add_u32 s3, s3, 66560
    v_add_u32 v178, s3, v251
    v_mov_b32 v179, 66560
    s_lshl_b32 s101, s2, 7
    s_add_u32 s101, s101, 131072
    s_lshl_b32 s3, s2, 2
    s_add_u32 s3, s3, s64
    s_lshl_b32 s3, s3, 7
    s_add_u32 s3, s3, 196608
    s_cmp_eq_u32 s64, 0
    s_cselect_b32 s101, s101, s3
    s_and_b32 s3, s2, 3
    s_lshl_b32 s3, s3, 11
    s_add_u32 s99, s99, s3
    s_lshl_b32 s3, s64, 9
    s_add_u32 s99, s99, s3
    s_add_u32 s99, s99, 4292608
    s_mov_b32 s97, 4096
    s_mov_b32 s86, 0x3ae38e39
    s_mov_b32 s87, 0x3727c5ac
    v_mov_b32 v238, 106240
    v_mov_b32 v239, 1
    s_lshl_b32 s92, s79, 7
    s_waitcnt vmcnt(5)
    s_mov_b64 exec, 1
    ds_add_rtn_u32 v253, v238, v239
    s_waitcnt lgkmcnt(0)
    v_readfirstlane_b32 s3, v253
    s_mov_b64 exec, -1
    s_cmp_eq_u32 s3, 2
    s_cbranch_scc0 nosig
    v_mov_b32 v238, s92
    v_mov_b32 v239, s83
    s_mov_b64 exec, 1
    buffer_store_dword v239, v238, s[56:59], 0 offen sc1
    s_mov_b64 exec, -1
    s_waitcnt vmcnt(1)
    s_branch have_h
nosig:
    s_waitcnt vmcnt(0)
    s_branch have_h
w3_path:
    v_mov_b32 v180, 0
    v_mov_b32 v181, 0
    v_mov_b32 v182, 0
    v_mov_b32 v183, 0
    v_add_u32 v176, s75, v251
    v_mov_b32 v177, s75
    v_mov_b32 v179, 66560
    v_mov_b32 v56, 106240
    ds_write_b32 v56, v180
    v_and_b32 v1, 15, v250
    v_lshrrev_b32 v2, 4, v250
    v_and_b32 v3, 3, v1
    v_cmp_eq_u32 vcc, 3, v3
    v_mul_u32_u24 v3, 4160, v3
    v_and_b32 v4, 12, v1
    v_lshlrev_b32 v4, 1, v4
    v_add_u32 v3, v3, v4
    v_cndmask_b32 v4, 0, 8, vcc
    v_add_u32 v3, v3, v4
    v_lshl_add_u32 v3, v2, 4, v3
    v_add_u32 v5, s75, v3
    s_lshl_b32 s93, s64, 7
    s_add_u32 s3, s93, 66560
    v_add_u32 v6, s3, v3
    s_waitcnt lgkmcnt(0)
    s_mov_b32 s36, s10
    s_mov_b32 s37, s11
    s_mov_b32 s38, 2359296
    s_mov_b32 s39, 0x00020000
    s_add_u32 s56, s20, 9691136
    s_addc_u32 s57, s21, 0
    s_mov_b32 s58, 327680
    s_mov_b32 s59, 0x00020000
    s_mov_b32 s40, s20
    s_mov_b32 s41, s21
    s_mov_b32 s42, 4866048
    s_mov_b32 s43, 0x00020000
    s_add_u32 s44, s20, 4866048
    s_addc_u32 s45, s21, 0
    s_mov_b32 s46, 4825088
    s_mov_b32 s47, 0x00020000
    s_mov_b32 s52, s16
    s_mov_b32 s53, s17
    s_mov_b32 s54, 2359296
    s_mov_b32 s55, 0x00020000
    s_lshr_b32 s90, s72, 1
    s_lshl_b32 s90, s90, 2
    s_lshr_b32 s91, s73, 1
    s_lshl_b32 s91, s91, 2
    s_load_dword s77, s[12:13], s90
    s_load_dword s78, s[12:13], s91
    v_mov_b32 v253, 163840
    buffer_load_dword v254, v253, s[56:59], 0 offen sc1
    s_waitcnt lgkmcnt(0)
    v_add_u32 v8, s76, v251
    s_add_u32 s3, s93, 101120
    v_add_u32 v9, s3, v251
    v_cmp_gt_u32 vcc, 32, v250
    s_mov_b32 exec_hi, 0xff
    s_nop 0
    v_cndmask_b32 v8, v9, v8, vcc
    ds_write_b128 v8, v[180:183] offset:4096
    s_mov_b64 exec, -1
    s_and_b32 s3, s72, 1
    s_lshl_b32 s3, s3, 4
    s_lshr_b32 s77, s77, s3
    s_and_b32 s77, s77, 0xffff
    s_and_b32 s3, s73, 1
    s_lshl_b32 s3, s3, 4
    s_lshr_b32 s78, s78, s3
    s_and_b32 s78, s78, 0xffff
    s_lshl_b32 s78, s78, 16
    v_lshlrev_b32 v3, 3, v2
    v_add_u32 v3, v3, v1
    v_sub_u32 v3, 15, v3
    v_and_b32 v4, 1, v3
    v_lshlrev_b32 v4, 4, v4
    v_ashrrev_i32 v3, 1, v3
    v_lshlrev_b32 v8, v4, s77
    v_cmp_eq_u32 vcc, 0, v3
    s_nop 1
    v_cndmask_b32 v216, 0, v8, vcc
    v_cmp_eq_u32 vcc, 1, v3
    s_nop 1
    v_cndmask_b32 v217, 0, v8, vcc
    v_cmp_eq_u32 vcc, 2, v3
    s_nop 1
    v_cndmask_b32 v218, 0, v8, vcc
    v_cmp_eq_u32 vcc, 3, v3
    s_nop 1
    v_cndmask_b32 v219, 0, v8, vcc
    v_lshlrev_b32 v3, 4, v2
    v_lshlrev_b32 v4, 5, v1
    v_sub_u32 v3, v3, v4
    v_add_u32 v3, 480, v3
    v_add_u32 v7, s76, v3
    s_add_u32 s3, s93, 101632
    v_add_u32 v226, s3, v3
    v_lshlrev_b32 v3, 3, v2
    v_add_u32 v3, v3, v4
    s_lshl_b32 s3, s74, 9
    s_sub_u32 s3, 105720, s3
    v_sub_u32 v231, s3, v3
    s_lshl_b32 s3, s64, 9
    s_add_u32 s3, s3, 124736
    v_add_u32 v227, s3, v3
    v_add_u32 v228, s3, v251
    s_lshl_b32 s3, s64, 10
    s_add_u32 s3, s3, 127296
    v_add_u32 v229, s3, v251
    s_lshl_b32 s3, s64, 12
    s_add_u32 s3, s3, 127296
    v_add_u32 v230, s3, v251
    v_mul_u32_u24 v224, 144, v1
    v_lshrrev_b32 v3, 1, v2
    v_lshl_add_u32 v224, v3, 6, v224
    v_and_b32 v3, 1, v2
    v_lshl_add_u32 v224, v3, 3, v224
    s_lshl_b32 s3, s64, 4
    s_add_u32 s3, s3, 106304
    v_add_u32 v224, s3, v224
    v_lshrrev_b32 v3, 3, v250
    v_mul_u32_u24 v225, 144, v3
    v_and_b32 v4, 7, v250
    v_lshl_add_u32 v225, v4, 4, v225
    s_mul_i32 s3, s64, 1152
    s_add_u32 s3, s3, 106304
    v_add_u32 v225, s3, v225
    v_mul_u32_u24 v234, 1028, v4
    v_lshl_add_u32 v234, v3, 4, v234
    s_lshr_b32 s88, s64, 1
    s_mul_i32 s89, s88, 9264
    s_and_b32 s3, s64, 1
    s_lshl_b32 s3, s3, 9
    s_add_u32 s89, s89, s3
    s_add_u32 s89, s89, 0
    v_add_u32 v234, s89, v234
    s_add_u32 s89, s89, 8224
    v_and_b32 v8, 3, v3
    v_lshl_add_u32 v235, v8, 2, v251
    v_xor_b32 v8, s64, v8
    v_lshl_add_u32 v237, v8, 2, v251
    s_mov_b32 s98, s89
    v_lshlrev_b32 v236, 6, v250
    s_mul_i32 s88, s2, 16768
    s_lshl_b32 s3, s64, 12
    s_add_u32 s88, s88, s3
    s_lshr_b32 s89, s2, 2
    s_mul_i32 s89, s89, 8320
    s_mov_b32 s99, s89
    s_lshl_b32 s3, s64, 11
    s_add_u32 s89, s89, s3
    s_and_b32 s3, s2, 3
    s_lshl_b32 s3, s3, 4
    s_add_u32 s89, s89, s3
    s_add_u32 s89, s89, 4292608
    v_lshrrev_b32 v4, 2, v250
    v_and_b32 v8, 3, v250
    v_lshlrev_b32 v8, 4, v8
    v_mul_u32_u24 v3, 16768, v4
    v_add_u32 v3, v3, v8
    v_mul_u32_u24 v4, 8320, v4
    v_add_u32 v4, v4, v8
    s_mul_i32 s80, s64, 268288
    s_lshl_b32 s3, s62, 13
    s_add_u32 s80, s80, s3
    s_sub_u32 s3, s72, s64
    s_lshl_b32 s3, s3, 4
    s_add_u32 s80, s80, s3
    s_mul_i32 s81, s74, 66560
    s_lshl_b32 s3, s62, 12
    s_add_u32 s81, s81, s3
    s_lshl_b32 s3, s63, 6
    s_add_u32 s81, s81, s3
    s_add_u32 s81, s81, 4292608
    s_mov_b32 s48, s14
    s_mov_b32 s49, s15
    s_mov_b32 s50, 2359296
    s_mov_b32 s51, 0x00020000
    s_lshl_b32 s84, s2, 3
    s_lshl_b32 s3, s64, 1
    s_add_u32 s84, s84, s3
    s_mul_i32 s84, s84, 1152
    s_mul_i32 s3, s62, 576
    s_add_u32 s90, s3, s72
    s_mul_i32 s90, s90, 4224
    s_add_u32 s91, s3, s73
    s_mul_i32 s91, s91, 4224
    s_lshl_b32 s85, s64, 10
    s_add_u32 s91, s91, s85
    s_add_u32 s85, s85, 101632
    s_lshl_b32 s92, s62, 1
    s_lshr_b32 s3, s63, 5
    s_add_u32 s92, s92, s3
    s_lshl_b32 s92, s92, 2
    s_add_u32 s92, s92, s64
    s_lshl_b32 s92, s92, 11
    v_and_b32 v8, 15, v1
    v_lshl_add_u32 v232, v8, 7, s92
    s_lshl_b32 s92, s64, 13
    s_add_u32 s92, s92, 131072
    v_lshl_add_u32 v233, v250, 7, s92
    v_add_u32 v176, s75, v251
    v_mov_b32 v177, s75
    s_lshl_b32 s3, s64, 10
    s_add_u32 s3, s3, 66560
    v_add_u32 v178, s3, v251
    v_mov_b32 v179, 66560
    s_lshl_b32 s101, s2, 7
    s_add_u32 s101, s101, 131072
    s_lshl_b32 s3, s2, 2
    s_add_u32 s3, s3, s64
    s_lshl_b32 s3, s3, 7
    s_add_u32 s3, s3, 196608
    s_cmp_eq_u32 s64, 0
    s_cselect_b32 s101, s101, s3
    s_and_b32 s3, s2, 3
    s_lshl_b32 s3, s3, 11
    s_add_u32 s99, s99, s3
    s_lshl_b32 s3, s64, 9
    s_add_u32 s99, s99, s3
    s_add_u32 s99, s99, 4292608
    s_mov_b32 s97, 4096
    s_mov_b32 s86, 0x3ae38e39
    s_mov_b32 s87, 0x3727c5ac
    s_waitcnt vmcnt(0)
    v_readfirstlane_b32 s83, v254
    s_mul_i32 s83, s83, 0x9E3779B1
    s_add_u32 s83, s83, 0x7F4A7C15
    s_waitcnt lgkmcnt(0)
    s_barrier
    s_lshl_b32 s3, s72, 12
    s_add_u32 s92, s75, 12512
    s_mov_b32 m0, s92
    s_nop 0
    buffer_load_dwordx4 v251, s[36:39], s3 offen offset:0  lds
    buffer_load_dwordx4 v251, s[36:39], s3 offen offset:1024  lds
    buffer_load_dwordx4 v251, s[36:39], s3 offen offset:2048  lds
    buffer_load_dwordx4 v251, s[36:39], s3 offen offset:3072  lds
    s_lshl_b32 s3, s73, 12
    s_lshl_b32 s92, s64, 10
    s_add_u32 s3, s3, s92
    s_add_u32 s92, s92, 79072
    s_mov_b32 m0, s92
    s_nop 0
    buffer_load_dwordx4 v251, s[36:39], s3 offen  lds
    s_waitcnt vmcnt(0)
have_h:
    ds_read_b128 v[120:123], v176 offset:12512
    ds_read_b64 v[124:125], v176 offset:12528
    ds_read_b128 v[128:131], v176 offset:13536
    ds_read_b64 v[132:133], v176 offset:13552
    ds_read_b64 v[138:139], v177 offset:12512
    s_waitcnt lgkmcnt(3)
    v_alignbit_b32 v144, v121, v120, 16
    v_alignbit_b32 v145, v122, v121, 16
    v_alignbit_b32 v146, v123, v122, 16
    v_alignbit_b32 v147, v124, v123, 16
    v_alignbit_b32 v156, v125, v124, 16
    v_pk_mov_b32 v[148:149], v[120:121], v[122:123] op_sel:[1,0]
    v_pk_mov_b32 v[150:151], v[122:123], v[124:125] op_sel:[1,0]
    v_pk_mov_b32 v[152:153], v[144:145], v[146:147] op_sel:[1,0]
    v_pk_mov_b32 v[154:155], v[146:147], v[156:157] op_sel:[1,0]
    ds_write_b128 v176, v[144:147] offset:32
    ds_write_b128 v176, v[148:151] offset:4192
    ds_write_b128 v176, v[152:155] offset:8352
    s_waitcnt lgkmcnt(4)
    v_alignbit_b32 v160, v129, v128, 16
    v_alignbit_b32 v161, v130, v129, 16
    v_alignbit_b32 v162, v131, v130, 16
    v_alignbit_b32 v163, v132, v131, 16
    v_alignbit_b32 v172, v133, v132, 16
    v_pk_mov_b32 v[164:165], v[128:129], v[130:131] op_sel:[1,0]
    v_pk_mov_b32 v[166:167], v[130:131], v[132:133] op_sel:[1,0]
    v_pk_mov_b32 v[168:169], v[160:161], v[162:163] op_sel:[1,0]
    v_pk_mov_b32 v[170:171], v[162:163], v[172:173] op_sel:[1,0]
    ds_write_b128 v176, v[160:163] offset:1056
    ds_write_b128 v176, v[164:167] offset:5216
    ds_write_b128 v176, v[168:171] offset:9376
    v_sub_u32 v137, 3, v250
    v_lshlrev_b32 v137, 4, v137
    s_waitcnt lgkmcnt(6)
    v_lshlrev_b64 v[138:139], v137, v[138:139]
    v_cmp_eq_u32 vcc, 3, v250
    v_mul_u32_u24 v137, 4160, v250
    v_add_u32 v140, v137, v177
    v_cndmask_b32 v138, v138, 0, vcc
    v_cndmask_b32 v139, v139, 0, vcc
    v_mov_b32 v136, 0
    v_mov_b32 v137, 0
    s_mov_b64 exec, 15
    ds_write_b128 v140, v[180:183]
    ds_write_b128 v140, v[136:139] offset:16
    s_mov_b64 exec, -1
    ds_read_b64 a[0:1], v5 offset:0
    ds_read_b64 a[2:3], v5 offset:8
    ds_read_b64 a[32:33], v5 offset:512
    ds_read_b64 a[34:35], v5 offset:520
    ds_read_b64 a[64:65], v5 offset:1024
    ds_read_b64 a[66:67], v5 offset:1032
    ds_read_b64 a[96:97], v5 offset:1536
    ds_read_b64 a[98:99], v5 offset:1544
    ds_read_b64 a[4:5], v5 offset:64
    ds_read_b64 a[6:7], v5 offset:72
    ds_read_b64 a[36:37], v5 offset:576
    ds_read_b64 a[38:39], v5 offset:584
    ds_read_b64 a[68:69], v5 offset:1088
    ds_read_b64 a[70:71], v5 offset:1096
    ds_read_b64 a[100:101], v5 offset:1600
    ds_read_b64 a[102:103], v5 offset:1608
    ds_read_b64 a[8:9], v5 offset:128
    ds_read_b64 a[10:11], v5 offset:136
    ds_read_b64 a[40:41], v5 offset:640
    ds_read_b64 a[42:43], v5 offset:648
    ds_read_b64 a[72:73], v5 offset:1152
    ds_read_b64 a[74:75], v5 offset:1160
    ds_read_b64 a[104:105], v5 offset:1664
    ds_read_b64 a[106:107], v5 offset:1672
    ds_read_b64 a[12:13], v5 offset:192
    ds_read_b64 a[14:15], v5 offset:200
    ds_read_b64 a[44:45], v5 offset:704
    ds_read_b64 a[46:47], v5 offset:712
    ds_read_b64 a[76:77], v5 offset:1216
    ds_read_b64 a[78:79], v5 offset:1224
    ds_read_b64 a[108:109], v5 offset:1728
    ds_read_b64 a[110:111], v5 offset:1736
    ds_read_b64 a[16:17], v5 offset:256
    ds_read_b64 a[18:19], v5 offset:264
    ds_read_b64 a[48:49], v5 offset:768
    ds_read_b64 a[50:51], v5 offset:776
    ds_read_b64 a[80:81], v5 offset:1280
    ds_read_b64 a[82:83], v5 offset:1288
    ds_read_b64 a[112:113], v5 offset:1792
    ds_read_b64 a[114:115], v5 offset:1800
    ds_read_b64 a[20:21], v5 offset:320
    ds_read_b64 a[22:23], v5 offset:328
    ds_read_b64 a[52:53], v5 offset:832
    ds_read_b64 a[54:55], v5 offset:840
    ds_read_b64 a[84:85], v5 offset:1344
    ds_read_b64 a[86:87], v5 offset:1352
    ds_read_b64 a[116:117], v5 offset:1856
    ds_read_b64 a[118:119], v5 offset:1864
    ds_read_b64 a[24:25], v5 offset:384
    ds_read_b64 a[26:27], v5 offset:392
    ds_read_b64 a[56:57], v5 offset:896
    ds_read_b64 a[58:59], v5 offset:904
    ds_read_b64 a[88:89], v5 offset:1408
    ds_read_b64 a[90:91], v5 offset:1416
    ds_read_b64 a[120:121], v5 offset:1920
    ds_read_b64 a[122:123], v5 offset:1928
    ds_read_b64 a[28:29], v5 offset:448
    ds_read_b64 a[30:31], v5 offset:456
    ds_read_b64 a[60:61], v5 offset:960
    ds_read_b64 a[62:63], v5 offset:968
    ds_read_b64 a[92:93], v5 offset:1472
    ds_read_b64 a[94:95], v5 offset:1480
    ds_read_b64 a[124:125], v5 offset:1984
    ds_read_b64 a[126:127], v5 offset:1992
part2:
    s_mov_b32 s92, 0x20000
e1_poll:
    buffer_load_dword v238, v232, s[56:59], 0 offen sc1
e1_chk:
    s_waitcnt vmcnt(0)
    v_cmp_ne_u32 vcc, s83, v238
    s_and_b64 exec, exec, vcc
    s_cbranch_execz e1_ok
    s_sleep 2
    s_sub_u32 s92, s92, 1
    s_cmp_lg_u32 s92, 0
    s_cbranch_scc1 e1_poll
e1_ok:
    s_mov_b64 exec, -1
    s_barrier
    s_mov_b32 m0, s76
    s_nop 0
    buffer_load_dwordx4 v251, s[40:43], s90 offen offset:3072 sc1 lds
    buffer_load_dwordx4 v251, s[40:43], s90 offen offset:2048 sc1 lds
    buffer_load_dwordx4 v251, s[40:43], s90 offen offset:1024 sc1 lds
    buffer_load_dwordx4 v251, s[40:43], s90 offen offset:0 sc1 lds
    s_mov_b32 m0, s85
    s_nop 0
    buffer_load_dwordx4 v251, s[40:43], s91 offen sc1 lds
    v_mov_b32 v184, -1
    v_mov_b32 v185, -1
    v_mov_b32 v186, -1
    v_mov_b32 v187, -1
    ds_read_b128 v[120:123], v176 offset:14560
    ds_read_b64 v[124:125], v176 offset:14576
    ds_read_b128 v[128:131], v176 offset:15584
    ds_read_b64 v[132:133], v176 offset:15600
    s_waitcnt lgkmcnt(2)
    v_alignbit_b32 v144, v121, v120, 16
    v_alignbit_b32 v145, v122, v121, 16
    v_alignbit_b32 v146, v123, v122, 16
    v_alignbit_b32 v147, v124, v123, 16
    v_alignbit_b32 v156, v125, v124, 16
    v_pk_mov_b32 v[148:149], v[120:121], v[122:123] op_sel:[1,0]
    v_pk_mov_b32 v[150:151], v[122:123], v[124:125] op_sel:[1,0]
    v_pk_mov_b32 v[152:153], v[144:145], v[146:147] op_sel:[1,0]
    v_pk_mov_b32 v[154:155], v[146:147], v[156:157] op_sel:[1,0]
    ds_write_b128 v176, v[144:147] offset:2080
    ds_write_b128 v176, v[148:151] offset:6240
    ds_write_b128 v176, v[152:155] offset:10400
    s_waitcnt lgkmcnt(3)
    v_alignbit_b32 v160, v129, v128, 16
    v_alignbit_b32 v161, v130, v129, 16
    v_alignbit_b32 v162, v131, v130, 16
    v_alignbit_b32 v163, v132, v131, 16
    v_alignbit_b32 v172, v133, v132, 16
    v_pk_mov_b32 v[164:165], v[128:129], v[130:131] op_sel:[1,0]
    v_pk_mov_b32 v[166:167], v[130:131], v[132:133] op_sel:[1,0]
    v_pk_mov_b32 v[168:169], v[160:161], v[162:163] op_sel:[1,0]
    v_pk_mov_b32 v[170:171], v[162:163], v[172:173] op_sel:[1,0]
    ds_write_b128 v176, v[160:163] offset:3104
    ds_write_b128 v176, v[164:167] offset:7264
    ds_write_b128 v176, v[168:171] offset:11424
    ds_read_b128 v[120:123], v178 offset:12512
    ds_read_b64 v[124:125], v178 offset:12528
    ds_read_b64 v[138:139], v179 offset:12512
    s_waitcnt lgkmcnt(1)
    v_alignbit_b32 v144, v121, v120, 16
    v_alignbit_b32 v145, v122, v121, 16
    v_alignbit_b32 v146, v123, v122, 16
    v_alignbit_b32 v147, v124, v123, 16
    v_alignbit_b32 v156, v125, v124, 16
    v_pk_mov_b32 v[148:149], v[120:121], v[122:123] op_sel:[1,0]
    v_pk_mov_b32 v[150:151], v[122:123], v[124:125] op_sel:[1,0]
    v_pk_mov_b32 v[152:153], v[144:145], v[146:147] op_sel:[1,0]
    v_pk_mov_b32 v[154:155], v[146:147], v[156:157] op_sel:[1,0]
    ds_write_b128 v178, v[144:147] offset:32
    ds_write_b128 v178, v[148:151] offset:4192
    ds_write_b128 v178, v[152:155] offset:8352
    v_sub_u32 v137, 3, v250
    v_lshlrev_b32 v137, 4, v137
    s_waitcnt lgkmcnt(3)
    v_lshlrev_b64 v[138:139], v137, v[138:139]
    v_cmp_eq_u32 vcc, 3, v250
    v_mul_u32_u24 v137, 4160, v250
    v_add_u32 v140, v137, v179
    v_cndmask_b32 v138, v138, 0, vcc
    v_cndmask_b32 v139, v139, 0, vcc
    v_mov_b32 v136, 0
    v_mov_b32 v137, 0
    s_mov_b64 exec, 15
    ds_write_b128 v140, v[180:183]
    ds_write_b128 v140, v[136:139] offset:16
    s_mov_b64 exec, -1
    s_waitcnt vmcnt(3)
    ds_read_b128 v[56:59], v7 offset:3584
    ds_read_b128 v[60:63], v7 offset:3072
    ds_read_b128 v[64:67], v7 offset:2560
    ds_read_b128 v[68:71], v7 offset:2048
    ds_read_b128 v[72:75], v7 offset:3648
    ds_read_b128 v[76:79], v7 offset:3136
    ds_read_b128 v[80:83], v7 offset:2624
    ds_read_b128 v[84:87], v7 offset:2112
    s_waitcnt lgkmcnt(7)
    v_mfma_f32_16x16x32_bf16 v[8:11], v[216:219], v[56:59], 0
    ds_read_b128 v[88:91], v7 offset:3712
    v_mfma_f32_16x16x32_bf16 v[8:11], a[0:3], v[56:59], v[8:11]
    ds_read_b128 v[92:95], v7 offset:3200
    v_mfma_f32_16x16x32_bf16 v[12:15], a[32:35], v[56:59], 0
    ds_read_b128 v[96:99], v7 offset:2688
    v_mfma_f32_16x16x32_bf16 v[16:19], a[64:67], v[56:59], 0
    ds_read_b128 v[100:103], v7 offset:2176
    v_mfma_f32_16x16x32_bf16 v[20:23], a[96:99], v[56:59], 0
    ds_read_b64 a[128:129], v5 offset:2048
    s_waitcnt lgkmcnt(11)
    v_mfma_f32_16x16x32_bf16 v[12:15], v[216:219], v[60:63], v[12:15]
    ds_read_b64 a[130:131], v5 offset:2056
    v_mfma_f32_16x16x32_bf16 v[12:15], a[0:3], v[60:63], v[12:15]
    buffer_store_dwordx4 v[184:187], v251, s[44:47], s88 offen offset:0 sc1
    v_mfma_f32_16x16x32_bf16 v[16:19], a[32:35], v[60:63], v[16:19]
    ds_read_b64 a[160:161], v5 offset:2560
    v_mfma_f32_16x16x32_bf16 v[20:23], a[64:67], v[60:63], v[20:23]
    buffer_store_dwordx4 v[184:187], v251, s[44:47], s88 offen offset:1024 sc1
    s_waitcnt lgkmcnt(12)
    v_mfma_f32_16x16x32_bf16 v[16:19], v[216:219], v[64:67], v[16:19]
    ds_read_b64 a[162:163], v5 offset:2568
    v_mfma_f32_16x16x32_bf16 v[16:19], a[0:3], v[64:67], v[16:19]
    buffer_store_dwordx4 v[184:187], v251, s[44:47], s88 offen offset:2048 sc1
    v_mfma_f32_16x16x32_bf16 v[20:23], a[32:35], v[64:67], v[20:23]
    ds_read_b64 a[192:193], v5 offset:3072
    s_waitcnt lgkmcnt(13)
    v_mfma_f32_16x16x32_bf16 v[20:23], v[216:219], v[68:71], v[20:23]
    buffer_store_dwordx4 v[184:187], v251, s[44:47], s88 offen offset:3072 sc1
    v_mfma_f32_16x16x32_bf16 v[20:23], a[0:3], v[68:71], v[20:23]
    ds_read_b64 a[194:195], v5 offset:3080
    s_waitcnt lgkmcnt(13)
    v_mfma_f32_16x16x32_bf16 v[8:11], a[4:7], v[72:75], v[8:11]
    ds_read_b128 v[104:107], v7 offset:3776
    v_mfma_f32_16x16x32_bf16 v[12:15], a[36:39], v[72:75], v[12:15]
    ds_read_b128 v[108:111], v7 offset:3264
    v_mfma_f32_16x16x32_bf16 v[16:19], a[68:71], v[72:75], v[16:19]
    ds_read_b128 v[112:115], v7 offset:2752
    v_mfma_f32_16x16x32_bf16 v[20:23], a[100:103], v[72:75], v[20:23]
    ds_read_b128 v[116:119], v7 offset:2240
    s_waitcnt lgkmcnt(15)
    v_mfma_f32_16x16x32_bf16 v[12:15], a[4:7], v[76:79], v[12:15]
    s_mov_b32 exec_hi, 0
    buffer_store_dwordx4 v[184:187], v251, s[44:47], s99 offen sc1
    s_mov_b64 exec, -1
    v_mfma_f32_16x16x32_bf16 v[16:19], a[36:39], v[76:79], v[16:19]
    ds_read_b64 a[224:225], v5 offset:3584
    v_mfma_f32_16x16x32_bf16 v[20:23], a[68:71], v[76:79], v[20:23]
    ds_read_b64 a[226:227], v5 offset:3592
    v_mfma_f32_16x16x32_bf16 v[16:19], a[4:7], v[80:83], v[16:19]
    ds_read_b64 a[132:133], v5 offset:2112
    v_mfma_f32_16x16x32_bf16 v[20:23], a[36:39], v[80:83], v[20:23]
    ds_read_b64 a[134:135], v5 offset:2120
    s_waitcnt lgkmcnt(15)
    v_mfma_f32_16x16x32_bf16 v[20:23], a[4:7], v[84:87], v[20:23]
    ds_read_b64 a[164:165], v5 offset:2624
    v_mfma_f32_16x16x32_bf16 v[8:11], a[8:11], v[88:91], v[8:11]
    ds_read_b128 v[56:59], v7 offset:3840
    v_mfma_f32_16x16x32_bf16 v[12:15], a[40:43], v[88:91], v[12:15]
    ds_read_b128 v[60:63], v7 offset:3328
    v_mfma_f32_16x16x32_bf16 v[16:19], a[72:75], v[88:91], v[16:19]
    ds_read_b128 v[64:67], v7 offset:2816
    v_mfma_f32_16x16x32_bf16 v[20:23], a[104:107], v[88:91], v[20:23]
    ds_read_b128 v[68:71], v7 offset:2304
    v_mfma_f32_16x16x32_bf16 v[12:15], a[8:11], v[92:95], v[12:15]
    ds_read_b64 a[166:167], v5 offset:2632
    v_mfma_f32_16x16x32_bf16 v[16:19], a[40:43], v[92:95], v[16:19]
    ds_read_b64 a[196:197], v5 offset:3136
    v_mfma_f32_16x16x32_bf16 v[20:23], a[72:75], v[92:95], v[20:23]
    ds_read_b64 a[198:199], v5 offset:3144
    v_mfma_f32_16x16x32_bf16 v[16:19], a[8:11], v[96:99], v[16:19]
    ds_read_b64 a[228:229], v5 offset:3648
    v_mfma_f32_16x16x32_bf16 v[20:23], a[40:43], v[96:99], v[20:23]
    ds_read_b64 a[230:231], v5 offset:3656
    s_waitcnt lgkmcnt(15)
    v_mfma_f32_16x16x32_bf16 v[20:23], a[8:11], v[100:103], v[20:23]
    ds_read_b64 a[136:137], v5 offset:2176
    v_mfma_f32_16x16x32_bf16 v[8:11], a[12:15], v[104:107], v[8:11]
    ds_read_b128 v[72:75], v7 offset:3904
    v_mfma_f32_16x16x32_bf16 v[12:15], a[44:47], v[104:107], v[12:15]
    ds_read_b128 v[76:79], v7 offset:3392
    v_mfma_f32_16x16x32_bf16 v[16:19], a[76:79], v[104:107], v[16:19]
    ds_read_b128 v[80:83], v7 offset:2880
    v_mfma_f32_16x16x32_bf16 v[20:23], a[108:111], v[104:107], v[20:23]
    ds_read_b128 v[84:87], v7 offset:2368
    v_mfma_f32_16x16x32_bf16 v[12:15], a[12:15], v[108:111], v[12:15]
    ds_read_b64 a[138:139], v5 offset:2184
    v_mfma_f32_16x16x32_bf16 v[16:19], a[44:47], v[108:111], v[16:19]
    ds_read_b64 a[168:169], v5 offset:2688
    v_mfma_f32_16x16x32_bf16 v[20:23], a[76:79], v[108:111], v[20:23]
    ds_read_b64 a[170:171], v5 offset:2696
    v_mfma_f32_16x16x32_bf16 v[16:19], a[12:15], v[112:115], v[16:19]
    ds_read_b64 a[200:201], v5 offset:3200
    v_mfma_f32_16x16x32_bf16 v[20:23], a[44:47], v[112:115], v[20:23]
    ds_read_b64 a[202:203], v5 offset:3208
    s_waitcnt lgkmcnt(15)
    v_mfma_f32_16x16x32_bf16 v[20:23], a[12:15], v[116:119], v[20:23]
    ds_read_b64 a[232:233], v5 offset:3712
    v_mfma_f32_16x16x32_bf16 v[8:11], a[16:19], v[56:59], v[8:11]
    ds_read_b128 v[88:91], v7 offset:3968
    v_mfma_f32_16x16x32_bf16 v[12:15], a[48:51], v[56:59], v[12:15]
    ds_read_b128 v[92:95], v7 offset:3456
    v_mfma_f32_16x16x32_bf16 v[16:19], a[80:83], v[56:59], v[16:19]
    ds_read_b128 v[96:99], v7 offset:2944
    v_mfma_f32_16x16x32_bf16 v[20:23], a[112:115], v[56:59], v[20:23]
    ds_read_b128 v[100:103], v7 offset:2432
    v_mfma_f32_16x16x32_bf16 v[12:15], a[16:19], v[60:63], v[12:15]
    ds_read_b64 a[234:235], v5 offset:3720
    v_mfma_f32_16x16x32_bf16 v[16:19], a[48:51], v[60:63], v[16:19]
    ds_read_b64 a[140:141], v5 offset:2240
    v_mfma_f32_16x16x32_bf16 v[20:23], a[80:83], v[60:63], v[20:23]
    ds_read_b64 a[142:143], v5 offset:2248
    v_mfma_f32_16x16x32_bf16 v[16:19], a[16:19], v[64:67], v[16:19]
    ds_read_b64 a[172:173], v5 offset:2752
    v_mfma_f32_16x16x32_bf16 v[20:23], a[48:51], v[64:67], v[20:23]
    ds_read_b64 a[174:175], v5 offset:2760
    v_mfma_f32_16x16x32_bf16 v[20:23], a[16:19], v[68:71], v[20:23]
    ds_read_b64 a[204:205], v5 offset:3264
    s_waitcnt lgkmcnt(15)
    v_mfma_f32_16x16x32_bf16 v[8:11], a[20:23], v[72:75], v[8:11]
    ds_read_b128 v[104:107], v7 offset:4032
    v_mfma_f32_16x16x32_bf16 v[12:15], a[52:55], v[72:75], v[12:15]
    ds_read_b128 v[108:111], v7 offset:3520
    v_mfma_f32_16x16x32_bf16 v[16:19], a[84:87], v[72:75], v[16:19]
    ds_read_b128 v[112:115], v7 offset:3008
    v_mfma_f32_16x16x32_bf16 v[20:23], a[116:119], v[72:75], v[20:23]
    ds_read_b128 v[116:119], v7 offset:2496
    v_mfma_f32_16x16x32_bf16 v[12:15], a[20:23], v[76:79], v[12:15]
    ds_read_b64 a[206:207], v5 offset:3272
    v_mfma_f32_16x16x32_bf16 v[16:19], a[52:55], v[76:79], v[16:19]
    ds_read_b64 a[236:237], v5 offset:3776
    v_mfma_f32_16x16x32_bf16 v[20:23], a[84:87], v[76:79], v[20:23]
    ds_read_b64 a[238:239], v5 offset:3784
    v_mfma_f32_16x16x32_bf16 v[16:19], a[20:23], v[80:83], v[16:19]
    ds_read_b64 a[144:145], v5 offset:2304
    v_mfma_f32_16x16x32_bf16 v[20:23], a[52:55], v[80:83], v[20:23]
    ds_read_b64 a[146:147], v5 offset:2312
    v_mfma_f32_16x16x32_bf16 v[20:23], a[20:23], v[84:87], v[20:23]
    ds_read_b64 a[176:177], v5 offset:2816
    s_waitcnt lgkmcnt(15)
    v_mfma_f32_16x16x32_bf16 v[8:11], a[24:27], v[88:91], v[8:11]
    ds_read_b128 v[56:59], v7 offset:3584
    v_mfma_f32_16x16x32_bf16 v[12:15], a[56:59], v[88:91], v[12:15]
    ds_read_b128 v[60:63], v7 offset:3072
    v_mfma_f32_16x16x32_bf16 v[16:19], a[88:91], v[88:91], v[16:19]
    ds_read_b128 v[64:67], v7 offset:2560
    v_mfma_f32_16x16x32_bf16 v[20:23], a[120:123], v[88:91], v[20:23]
    ds_read_b128 v[68:71], v7 offset:2048
    v_mfma_f32_16x16x32_bf16 v[12:15], a[24:27], v[92:95], v[12:15]
    ds_read_b64 a[178:179], v5 offset:2824
    v_mfma_f32_16x16x32_bf16 v[16:19], a[56:59], v[92:95], v[16:19]
    ds_read_b64 a[208:209], v5 offset:3328
    v_mfma_f32_16x16x32_bf16 v[20:23], a[88:91], v[92:95], v[20:23]
    ds_read_b64 a[210:211], v5 offset:3336
    v_mfma_f32_16x16x32_bf16 v[16:19], a[24:27], v[96:99], v[16:19]
    ds_read_b64 a[240:241], v5 offset:3840
    v_mfma_f32_16x16x32_bf16 v[20:23], a[56:59], v[96:99], v[20:23]
    ds_read_b64 a[242:243], v5 offset:3848
    v_mfma_f32_16x16x32_bf16 v[20:23], a[24:27], v[100:103], v[20:23]
    ds_read_b64 a[148:149], v5 offset:2368
    s_waitcnt lgkmcnt(15)
    v_mfma_f32_16x16x32_bf16 v[8:11], a[28:31], v[104:107], v[8:11]
    ds_read_b128 v[72:75], v7 offset:3648
    v_mfma_f32_16x16x32_bf16 v[12:15], a[60:63], v[104:107], v[12:15]
    ds_read_b128 v[76:79], v7 offset:3136
    v_mfma_f32_16x16x32_bf16 v[16:19], a[92:95], v[104:107], v[16:19]
    ds_read_b128 v[80:83], v7 offset:2624
    v_mfma_f32_16x16x32_bf16 v[20:23], a[124:127], v[104:107], v[20:23]
    ds_read_b128 v[84:87], v7 offset:2112
    v_mfma_f32_16x16x32_bf16 v[12:15], a[28:31], v[108:111], v[12:15]
    ds_read_b64 a[150:151], v5 offset:2376
    v_mfma_f32_16x16x32_bf16 v[16:19], a[60:63], v[108:111], v[16:19]
    ds_read_b64 a[180:181], v5 offset:2880
    v_mfma_f32_16x16x32_bf16 v[20:23], a[92:95], v[108:111], v[20:23]
    ds_read_b64 a[182:183], v5 offset:2888
    v_mfma_f32_16x16x32_bf16 v[16:19], a[28:31], v[112:115], v[16:19]
    ds_read_b64 a[212:213], v5 offset:3392
    v_mfma_f32_16x16x32_bf16 v[20:23], a[60:63], v[112:115], v[20:23]
    ds_read_b64 a[214:215], v5 offset:3400
    v_mfma_f32_16x16x32_bf16 v[20:23], a[28:31], v[116:119], v[20:23]
    ds_read_b64 a[244:245], v5 offset:3904
    s_waitcnt lgkmcnt(15)
    v_mfma_f32_16x16x32_bf16 v[24:27], a[128:131], v[56:59], 0
    ds_read_b128 v[88:91], v7 offset:3712
    v_mfma_f32_16x16x32_bf16 v[28:31], a[160:163], v[56:59], 0
    ds_read_b128 v[92:95], v7 offset:3200
    v_mfma_f32_16x16x32_bf16 v[32:35], a[192:195], v[56:59], 0
    ds_read_b128 v[96:99], v7 offset:2688
    v_mfma_f32_16x16x32_bf16 v[36:39], a[224:227], v[56:59], 0
    ds_read_b128 v[100:103], v7 offset:2176
    v_mfma_f32_16x16x32_bf16 v[24:27], a[96:99], v[60:63], v[24:27]
    ds_read_b64 a[246:247], v5 offset:3912
    v_mfma_f32_16x16x32_bf16 v[28:31], a[128:131], v[60:63], v[28:31]
    ds_read_b64 a[152:153], v5 offset:2432
    v_mfma_f32_16x16x32_bf16 v[32:35], a[160:163], v[60:63], v[32:35]
    ds_read_b64 a[154:155], v5 offset:2440
    v_mfma_f32_16x16x32_bf16 v[36:39], a[192:195], v[60:63], v[36:39]
    ds_read_b64 a[184:185], v5 offset:2944
    v_mfma_f32_16x16x32_bf16 v[24:27], a[64:67], v[64:67], v[24:27]
    ds_read_b64 a[186:187], v5 offset:2952
    s_waitcnt vmcnt(0)
    s_barrier
    v_mov_b32 v238, s101
    v_mov_b32 v239, s83
    s_mov_b64 exec, 1
    buffer_store_dword v239, v238, s[56:59], 0 offen sc1
    s_mov_b64 exec, -1
    v_mfma_f32_16x16x32_bf16 v[28:31], a[96:99], v[64:67], v[28:31]
    ds_read_b64 a[216:217], v5 offset:3456
    v_mfma_f32_16x16x32_bf16 v[32:35], a[128:131], v[64:67], v[32:35]
    ds_read_b64 a[218:219], v5 offset:3464
    buffer_load_dwordx4 v[240:243], v251, s[48:51], s84 offen nt
    v_mfma_f32_16x16x32_bf16 v[36:39], a[160:163], v[64:67], v[36:39]
    ds_read_b64 a[248:249], v5 offset:3968
    v_mfma_f32_16x16x32_bf16 v[24:27], a[32:35], v[68:71], v[24:27]
    ds_read_b64 a[250:251], v5 offset:3976
    v_mfma_f32_16x16x32_bf16 v[28:31], a[64:67], v[68:71], v[28:31]
    ds_read_b64 a[156:157], v5 offset:2496
    buffer_load_dwordx4 v[244:247], v251, s[48:51], s84 offen offset:1152 nt
    v_mfma_f32_16x16x32_bf16 v[32:35], a[96:99], v[68:71], v[32:35]
    ds_read_b64 a[158:159], v5 offset:2504
    v_mfma_f32_16x16x32_bf16 v[36:39], a[128:131], v[68:71], v[36:39]
    ds_read_b64 a[188:189], v5 offset:3008
    s_waitcnt lgkmcnt(15)
    v_mfma_f32_16x16x32_bf16 v[24:27], a[132:135], v[72:75], v[24:27]
    ds_read_b128 v[104:107], v7 offset:3776
    v_mfma_f32_16x16x32_bf16 v[28:31], a[164:167], v[72:75], v[28:31]
    ds_read_b128 v[108:111], v7 offset:3264
    v_mfma_f32_16x16x32_bf16 v[32:35], a[196:199], v[72:75], v[32:35]
    ds_read_b128 v[112:115], v7 offset:2752
    v_mfma_f32_16x16x32_bf16 v[36:39], a[228:231], v[72:75], v[36:39]
    ds_read_b128 v[116:119], v7 offset:2240
    v_mfma_f32_16x16x32_bf16 v[24:27], a[100:103], v[76:79], v[24:27]
    ds_read_b64 a[190:191], v5 offset:3016
    v_mfma_f32_16x16x32_bf16 v[28:31], a[132:135], v[76:79], v[28:31]
    ds_read_b64 a[220:221], v5 offset:3520
    v_mfma_f32_16x16x32_bf16 v[32:35], a[164:167], v[76:79], v[32:35]
    ds_read_b64 a[222:223], v5 offset:3528
    v_mfma_f32_16x16x32_bf16 v[36:39], a[196:199], v[76:79], v[36:39]
    ds_read_b64 a[252:253], v5 offset:4032
    v_mfma_f32_16x16x32_bf16 v[24:27], a[68:71], v[80:83], v[24:27]
    ds_read_b64 a[254:255], v5 offset:4040
    v_mfma_f32_16x16x32_bf16 v[28:31], a[100:103], v[80:83], v[28:31]
    buffer_load_ushort v248, v252, s[48:51], s84 offen offset:1024 nt
    v_mfma_f32_16x16x32_bf16 v[32:35], a[132:135], v[80:83], v[32:35]
    buffer_load_ushort v249, v252, s[48:51], s84 offen offset:2176 nt
    v_mfma_f32_16x16x32_bf16 v[36:39], a[164:167], v[80:83], v[36:39]
    ds_read_b64 v[120:121], v6 offset:0
    v_mfma_f32_16x16x32_bf16 v[24:27], a[36:39], v[84:87], v[24:27]
    ds_read_b64 v[122:123], v6 offset:8
    v_mfma_f32_16x16x32_bf16 v[28:31], a[68:71], v[84:87], v[28:31]
    ds_read_b64 v[124:125], v6 offset:512
    v_mfma_f32_16x16x32_bf16 v[32:35], a[100:103], v[84:87], v[32:35]
    ds_read_b64 v[126:127], v6 offset:520
    v_mfma_f32_16x16x32_bf16 v[36:39], a[132:135], v[84:87], v[36:39]
    ds_read_b64 v[128:129], v6 offset:1024
    v_mfma_f32_16x16x32_bf16 v[24:27], a[136:139], v[88:91], v[24:27]
    ds_read_b128 v[56:59], v7 offset:3840
    v_mfma_f32_16x16x32_bf16 v[28:31], a[168:171], v[88:91], v[28:31]
    ds_read_b128 v[60:63], v7 offset:3328
    v_mfma_f32_16x16x32_bf16 v[32:35], a[200:203], v[88:91], v[32:35]
    ds_read_b128 v[64:67], v7 offset:2816
    v_mfma_f32_16x16x32_bf16 v[36:39], a[232:235], v[88:91], v[36:39]
    ds_read_b128 v[68:71], v7 offset:2304
    s_waitcnt lgkmcnt(15)
    v_mfma_f32_16x16x32_bf16 v[24:27], a[104:107], v[92:95], v[24:27]
    ds_read_b64 v[130:131], v6 offset:1032
    v_mfma_f32_16x16x32_bf16 v[28:31], a[136:139], v[92:95], v[28:31]
    ds_read_b64 v[132:133], v6 offset:1536
    v_mfma_f32_16x16x32_bf16 v[32:35], a[168:171], v[92:95], v[32:35]
    ds_read_b64 v[134:135], v6 offset:1544
    v_mfma_f32_16x16x32_bf16 v[36:39], a[200:203], v[92:95], v[36:39]
    ds_read_b64 v[136:137], v6 offset:2048
    v_mfma_f32_16x16x32_bf16 v[24:27], a[72:75], v[96:99], v[24:27]
    ds_read_b64 v[138:139], v6 offset:2056
    v_mfma_f32_16x16x32_bf16 v[28:31], a[104:107], v[96:99], v[28:31]
    ds_read_b64 v[140:141], v6 offset:2560
    v_mfma_f32_16x16x32_bf16 v[32:35], a[136:139], v[96:99], v[32:35]
    ds_read_b64 v[142:143], v6 offset:2568
    v_mfma_f32_16x16x32_bf16 v[36:39], a[168:171], v[96:99], v[36:39]
    ds_read_b64 v[144:145], v6 offset:3072
    v_mfma_f32_16x16x32_bf16 v[24:27], a[40:43], v[100:103], v[24:27]
    ds_read_b64 v[146:147], v6 offset:3080
    v_mfma_f32_16x16x32_bf16 v[28:31], a[72:75], v[100:103], v[28:31]
    ds_read_b64 v[148:149], v6 offset:3584
    v_mfma_f32_16x16x32_bf16 v[32:35], a[104:107], v[100:103], v[32:35]
    ds_read_b64 v[150:151], v6 offset:3592
    v_mfma_f32_16x16x32_bf16 v[36:39], a[136:139], v[100:103], v[36:39]
    ds_read_b64 v[152:153], v6 offset:64
    v_mfma_f32_16x16x32_bf16 v[24:27], a[140:143], v[104:107], v[24:27]
    ds_read_b128 v[72:75], v7 offset:3904
    v_mfma_f32_16x16x32_bf16 v[28:31], a[172:175], v[104:107], v[28:31]
    ds_read_b128 v[76:79], v7 offset:3392
    v_mfma_f32_16x16x32_bf16 v[32:35], a[204:207], v[104:107], v[32:35]
    ds_read_b128 v[80:83], v7 offset:2880
    v_mfma_f32_16x16x32_bf16 v[36:39], a[236:239], v[104:107], v[36:39]
    ds_read_b128 v[84:87], v7 offset:2368
    v_mfma_f32_16x16x32_bf16 v[24:27], a[108:111], v[108:111], v[24:27]
    ds_read_b64 v[154:155], v6 offset:72
    v_mfma_f32_16x16x32_bf16 v[28:31], a[140:143], v[108:111], v[28:31]
    ds_read_b64 v[156:157], v6 offset:576
    v_mfma_f32_16x16x32_bf16 v[32:35], a[172:175], v[108:111], v[32:35]
    ds_read_b64 v[158:159], v6 offset:584
    v_mfma_f32_16x16x32_bf16 v[36:39], a[204:207], v[108:111], v[36:39]
    ds_read_b64 v[160:161], v6 offset:1088
    v_mfma_f32_16x16x32_bf16 v[24:27], a[76:79], v[112:115], v[24:27]
    ds_read_b64 v[162:163], v6 offset:1096
    v_mfma_f32_16x16x32_bf16 v[28:31], a[108:111], v[112:115], v[28:31]
    ds_read_b64 v[164:165], v6 offset:1600
    v_mfma_f32_16x16x32_bf16 v[32:35], a[140:143], v[112:115], v[32:35]
    ds_read_b64 v[166:167], v6 offset:1608
    v_mfma_f32_16x16x32_bf16 v[36:39], a[172:175], v[112:115], v[36:39]
    ds_read_b64 v[168:169], v6 offset:2112
    s_waitcnt lgkmcnt(15)
    v_mfma_f32_16x16x32_bf16 v[24:27], a[44:47], v[116:119], v[24:27]
    ds_read_b64 v[170:171], v6 offset:2120
    v_mfma_f32_16x16x32_bf16 v[28:31], a[76:79], v[116:119], v[28:31]
    ds_read_b64 v[172:173], v6 offset:2624
    v_mfma_f32_16x16x32_bf16 v[32:35], a[108:111], v[116:119], v[32:35]
    ds_read_b64 v[174:175], v6 offset:2632
    v_mfma_f32_16x16x32_bf16 v[36:39], a[140:143], v[116:119], v[36:39]
    ds_read_b64 v[176:177], v6 offset:3136
    v_mfma_f32_16x16x32_bf16 v[24:27], a[144:147], v[56:59], v[24:27]
    ds_read_b128 v[88:91], v7 offset:3968
    v_mfma_f32_16x16x32_bf16 v[28:31], a[176:179], v[56:59], v[28:31]
    ds_read_b128 v[92:95], v7 offset:3456
    v_mfma_f32_16x16x32_bf16 v[32:35], a[208:211], v[56:59], v[32:35]
    ds_read_b128 v[96:99], v7 offset:2944
    v_mfma_f32_16x16x32_bf16 v[36:39], a[240:243], v[56:59], v[36:39]
    ds_read_b128 v[100:103], v7 offset:2432
    v_mfma_f32_16x16x32_bf16 v[24:27], a[112:115], v[60:63], v[24:27]
    ds_read_b64 v[178:179], v6 offset:3144
    v_mfma_f32_16x16x32_bf16 v[28:31], a[144:147], v[60:63], v[28:31]
    ds_read_b64 v[180:181], v6 offset:3648
    v_mfma_f32_16x16x32_bf16 v[32:35], a[176:179], v[60:63], v[32:35]
    ds_read_b64 v[182:183], v6 offset:3656
    v_mfma_f32_16x16x32_bf16 v[36:39], a[208:211], v[60:63], v[36:39]
    v_mfma_f32_16x16x32_bf16 v[24:27], a[80:83], v[64:67], v[24:27]
    v_mfma_f32_16x16x32_bf16 v[28:31], a[112:115], v[64:67], v[28:31]
    v_mfma_f32_16x16x32_bf16 v[32:35], a[144:147], v[64:67], v[32:35]
    v_mfma_f32_16x16x32_bf16 v[36:39], a[176:179], v[64:67], v[36:39]
    v_mfma_f32_16x16x32_bf16 v[24:27], a[48:51], v[68:71], v[24:27]
    v_mfma_f32_16x16x32_bf16 v[28:31], a[80:83], v[68:71], v[28:31]
    v_mfma_f32_16x16x32_bf16 v[32:35], a[112:115], v[68:71], v[32:35]
    v_mfma_f32_16x16x32_bf16 v[36:39], a[144:147], v[68:71], v[36:39]
    s_waitcnt lgkmcnt(15)
    v_mfma_f32_16x16x32_bf16 v[24:27], a[148:151], v[72:75], v[24:27]
    ds_read_b128 v[104:107], v7 offset:4032
    v_mfma_f32_16x16x32_bf16 v[28:31], a[180:183], v[72:75], v[28:31]
    ds_read_b128 v[108:111], v7 offset:3520
    v_mfma_f32_16x16x32_bf16 v[32:35], a[212:215], v[72:75], v[32:35]
    ds_read_b128 v[112:115], v7 offset:3008
    v_mfma_f32_16x16x32_bf16 v[36:39], a[244:247], v[72:75], v[36:39]
    ds_read_b128 v[116:119], v7 offset:2496
    v_mfma_f32_16x16x32_bf16 v[24:27], a[116:119], v[76:79], v[24:27]
    ds_read_b128 v[184:187], v226 offset:3584
    v_mfma_f32_16x16x32_bf16 v[28:31], a[148:151], v[76:79], v[28:31]
    ds_read_b128 v[188:191], v226 offset:3072
    v_mfma_f32_16x16x32_bf16 v[32:35], a[180:183], v[76:79], v[32:35]
    ds_read_b128 v[192:195], v226 offset:2560
    v_mfma_f32_16x16x32_bf16 v[36:39], a[212:215], v[76:79], v[36:39]
    ds_read_b128 v[196:199], v226 offset:2048
    v_mfma_f32_16x16x32_bf16 v[24:27], a[84:87], v[80:83], v[24:27]
    ds_read_b128 v[200:203], v226 offset:1536
    v_mfma_f32_16x16x32_bf16 v[28:31], a[116:119], v[80:83], v[28:31]
    ds_read_b128 v[204:207], v226 offset:1024
    v_mfma_f32_16x16x32_bf16 v[32:35], a[148:151], v[80:83], v[32:35]
    ds_read_b128 v[208:211], v226 offset:512
    v_mfma_f32_16x16x32_bf16 v[36:39], a[180:183], v[80:83], v[36:39]
    ds_read_b128 v[212:215], v226 offset:0
    v_mfma_f32_16x16x32_bf16 v[24:27], a[52:55], v[84:87], v[24:27]
    v_mfma_f32_16x16x32_bf16 v[28:31], a[84:87], v[84:87], v[28:31]
    v_mfma_f32_16x16x32_bf16 v[32:35], a[116:119], v[84:87], v[32:35]
    v_mfma_f32_16x16x32_bf16 v[36:39], a[148:151], v[84:87], v[36:39]
    s_cmp_eq_u32 s82, 1
    s_cbranch_scc1 ex_h1
    s_waitcnt lgkmcnt(7)
    v_mfma_f32_16x16x32_bf16 v[40:43], v[120:123], v[184:187], 0
    ds_read_b128 v[56:59], v226 offset:3648
    v_mfma_f32_16x16x32_bf16 v[44:47], v[128:131], v[184:187], 0
    ds_read_b128 v[60:63], v226 offset:3136
    v_mfma_f32_16x16x32_bf16 v[48:51], v[140:143], v[184:187], 0
    ds_read_b128 v[64:67], v226 offset:2624
    v_mfma_f32_16x16x32_bf16 v[52:55], v[148:151], v[184:187], 0
    ds_read_b128 v[68:71], v226 offset:2112
    s_waitcnt lgkmcnt(10)
    v_mfma_f32_16x16x32_bf16 v[44:47], v[124:127], v[188:191], v[44:47]
    ds_read_b128 v[72:75], v226 offset:1600
    v_mfma_f32_16x16x32_bf16 v[48:51], v[136:139], v[188:191], v[48:51]
    ds_read_b128 v[76:79], v226 offset:1088
    v_mfma_f32_16x16x32_bf16 v[52:55], v[144:147], v[188:191], v[52:55]
    ds_read_b128 v[80:83], v226 offset:576
    s_waitcnt lgkmcnt(12)
    v_mfma_f32_16x16x32_bf16 v[44:47], v[120:123], v[192:195], v[44:47]
    ds_read_b128 v[84:87], v226 offset:64
    v_mfma_f32_16x16x32_bf16 v[48:51], v[132:135], v[192:195], v[48:51]
    v_mfma_f32_16x16x32_bf16 v[52:55], v[140:143], v[192:195], v[52:55]
    v_cvt_pk_bf16_f32 v220, v8, v9
    s_waitcnt lgkmcnt(12)
    v_mfma_f32_16x16x32_bf16 v[48:51], v[128:131], v[196:199], v[48:51]
    v_cvt_pk_bf16_f32 v221, v10, v11
    v_mfma_f32_16x16x32_bf16 v[52:55], v[136:139], v[196:199], v[52:55]
    v_min_u32 v220, -2, v220
    s_waitcnt lgkmcnt(11)
    v_mfma_f32_16x16x32_bf16 v[48:51], v[124:127], v[200:203], v[48:51]
    v_min_u32 v221, -2, v221
    v_mfma_f32_16x16x32_bf16 v[52:55], v[132:135], v[200:203], v[52:55]
    ds_write_b64 v224, v[220:221] offset:0
    s_waitcnt lgkmcnt(11)
    v_mfma_f32_16x16x32_bf16 v[48:51], v[120:123], v[204:207], v[48:51]
    v_cvt_pk_bf16_f32 v222, v12, v13
    v_mfma_f32_16x16x32_bf16 v[52:55], v[128:131], v[204:207], v[52:55]
    v_cvt_pk_bf16_f32 v223, v14, v15
    s_waitcnt lgkmcnt(10)
    v_mfma_f32_16x16x32_bf16 v[52:55], v[124:127], v[208:211], v[52:55]
    v_min_u32 v222, -2, v222
    s_waitcnt lgkmcnt(9)
    v_mfma_f32_16x16x32_bf16 v[52:55], v[120:123], v[212:215], v[52:55]
    v_min_u32 v223, -2, v223
    s_waitcnt lgkmcnt(8)
    v_mfma_f32_16x16x32_bf16 v[40:43], v[152:155], v[56:59], v[40:43]
    ds_write_b64 v224, v[222:223] offset:2304
    v_mfma_f32_16x16x32_bf16 v[44:47], v[160:163], v[56:59], v[44:47]
    v_cvt_pk_bf16_f32 v220, v16, v17
    v_mfma_f32_16x16x32_bf16 v[48:51], v[172:175], v[56:59], v[48:51]
    v_cvt_pk_bf16_f32 v221, v18, v19
    v_mfma_f32_16x16x32_bf16 v[52:55], v[180:183], v[56:59], v[52:55]
    v_min_u32 v220, -2, v220
    s_waitcnt lgkmcnt(8)
    v_mfma_f32_16x16x32_bf16 v[44:47], v[156:159], v[60:63], v[44:47]
    v_min_u32 v221, -2, v221
    v_mfma_f32_16x16x32_bf16 v[48:51], v[168:171], v[60:63], v[48:51]
    ds_write_b64 v224, v[220:221] offset:4608
    v_mfma_f32_16x16x32_bf16 v[52:55], v[176:179], v[60:63], v[52:55]
    v_cvt_pk_bf16_f32 v222, v20, v21
    s_waitcnt lgkmcnt(8)
    v_mfma_f32_16x16x32_bf16 v[44:47], v[152:155], v[64:67], v[44:47]
    v_cvt_pk_bf16_f32 v223, v22, v23
    v_mfma_f32_16x16x32_bf16 v[48:51], v[164:167], v[64:67], v[48:51]
    v_min_u32 v222, -2, v222
    v_mfma_f32_16x16x32_bf16 v[52:55], v[172:175], v[64:67], v[52:55]
    v_min_u32 v223, -2, v223
    s_waitcnt lgkmcnt(7)
    v_mfma_f32_16x16x32_bf16 v[48:51], v[160:163], v[68:71], v[48:51]
    ds_write_b64 v224, v[222:223] offset:6912
    v_mfma_f32_16x16x32_bf16 v[52:55], v[168:171], v[68:71], v[52:55]
    s_waitcnt lgkmcnt(7)
    v_mfma_f32_16x16x32_bf16 v[48:51], v[156:159], v[72:75], v[48:51]
    v_mfma_f32_16x16x32_bf16 v[52:55], v[164:167], v[72:75], v[52:55]
    s_waitcnt lgkmcnt(6)
    v_mfma_f32_16x16x32_bf16 v[48:51], v[152:155], v[76:79], v[48:51]
    v_mfma_f32_16x16x32_bf16 v[52:55], v[160:163], v[76:79], v[52:55]
    s_waitcnt lgkmcnt(5)
    v_mfma_f32_16x16x32_bf16 v[52:55], v[156:159], v[80:83], v[52:55]
    s_waitcnt lgkmcnt(4)
    v_mfma_f32_16x16x32_bf16 v[52:55], v[152:155], v[84:87], v[52:55]
    s_branch ex_join
ex_h1:
    s_waitcnt lgkmcnt(7)
    v_mfma_f32_16x16x32_bf16 v[40:43], v[124:127], v[184:187], 0
    ds_read_b128 v[56:59], v226 offset:3648
    v_mfma_f32_16x16x32_bf16 v[44:47], v[132:135], v[184:187], 0
    ds_read_b128 v[60:63], v226 offset:3136
    v_mfma_f32_16x16x32_bf16 v[48:51], v[136:139], v[184:187], 0
    ds_read_b128 v[64:67], v226 offset:2624
    v_mfma_f32_16x16x32_bf16 v[52:55], v[144:147], v[184:187], 0
    ds_read_b128 v[68:71], v226 offset:2112
    s_waitcnt lgkmcnt(10)
    v_mfma_f32_16x16x32_bf16 v[40:43], v[120:123], v[188:191], v[40:43]
    ds_read_b128 v[72:75], v226 offset:1600
    v_mfma_f32_16x16x32_bf16 v[44:47], v[128:131], v[188:191], v[44:47]
    ds_read_b128 v[76:79], v226 offset:1088
    v_mfma_f32_16x16x32_bf16 v[48:51], v[132:135], v[188:191], v[48:51]
    ds_read_b128 v[80:83], v226 offset:576
    v_mfma_f32_16x16x32_bf16 v[52:55], v[140:143], v[188:191], v[52:55]
    ds_read_b128 v[84:87], v226 offset:64
    s_waitcnt lgkmcnt(13)
    v_mfma_f32_16x16x32_bf16 v[44:47], v[124:127], v[192:195], v[44:47]
    v_mfma_f32_16x16x32_bf16 v[48:51], v[128:131], v[192:195], v[48:51]
    v_cvt_pk_bf16_f32 v220, v8, v9
    v_mfma_f32_16x16x32_bf16 v[52:55], v[136:139], v[192:195], v[52:55]
    v_cvt_pk_bf16_f32 v221, v10, v11
    s_waitcnt lgkmcnt(12)
    v_mfma_f32_16x16x32_bf16 v[44:47], v[120:123], v[196:199], v[44:47]
    v_min_u32 v220, -2, v220
    v_mfma_f32_16x16x32_bf16 v[48:51], v[124:127], v[196:199], v[48:51]
    v_min_u32 v221, -2, v221
    v_mfma_f32_16x16x32_bf16 v[52:55], v[132:135], v[196:199], v[52:55]
    ds_write_b64 v224, v[220:221] offset:0
    s_waitcnt lgkmcnt(12)
    v_mfma_f32_16x16x32_bf16 v[48:51], v[120:123], v[200:203], v[48:51]
    v_cvt_pk_bf16_f32 v222, v12, v13
    v_mfma_f32_16x16x32_bf16 v[52:55], v[128:131], v[200:203], v[52:55]
    v_cvt_pk_bf16_f32 v223, v14, v15
    s_waitcnt lgkmcnt(11)
    v_mfma_f32_16x16x32_bf16 v[52:55], v[124:127], v[204:207], v[52:55]
    v_min_u32 v222, -2, v222
    s_waitcnt lgkmcnt(10)
    v_mfma_f32_16x16x32_bf16 v[52:55], v[120:123], v[208:211], v[52:55]
    v_min_u32 v223, -2, v223
    s_waitcnt lgkmcnt(8)
    v_mfma_f32_16x16x32_bf16 v[40:43], v[156:159], v[56:59], v[40:43]
    ds_write_b64 v224, v[222:223] offset:2304
    v_mfma_f32_16x16x32_bf16 v[44:47], v[164:167], v[56:59], v[44:47]
    v_cvt_pk_bf16_f32 v220, v16, v17
    v_mfma_f32_16x16x32_bf16 v[48:51], v[168:171], v[56:59], v[48:51]
    v_cvt_pk_bf16_f32 v221, v18, v19
    v_mfma_f32_16x16x32_bf16 v[52:55], v[176:179], v[56:59], v[52:55]
    v_min_u32 v220, -2, v220
    s_waitcnt lgkmcnt(8)
    v_mfma_f32_16x16x32_bf16 v[40:43], v[152:155], v[60:63], v[40:43]
    v_min_u32 v221, -2, v221
    v_mfma_f32_16x16x32_bf16 v[44:47], v[160:163], v[60:63], v[44:47]
    ds_write_b64 v224, v[220:221] offset:4608
    v_mfma_f32_16x16x32_bf16 v[48:51], v[164:167], v[60:63], v[48:51]
    v_cvt_pk_bf16_f32 v222, v20, v21
    v_mfma_f32_16x16x32_bf16 v[52:55], v[172:175], v[60:63], v[52:55]
    v_cvt_pk_bf16_f32 v223, v22, v23
    s_waitcnt lgkmcnt(8)
    v_mfma_f32_16x16x32_bf16 v[44:47], v[156:159], v[64:67], v[44:47]
    v_min_u32 v222, -2, v222
    v_mfma_f32_16x16x32_bf16 v[48:51], v[160:163], v[64:67], v[48:51]
    v_min_u32 v223, -2, v223
    v_mfma_f32_16x16x32_bf16 v[52:55], v[168:171], v[64:67], v[52:55]
    ds_write_b64 v224, v[222:223] offset:6912
    s_waitcnt lgkmcnt(8)
    v_mfma_f32_16x16x32_bf16 v[44:47], v[152:155], v[68:71], v[44:47]
    v_mfma_f32_16x16x32_bf16 v[48:51], v[156:159], v[68:71], v[48:51]
    v_mfma_f32_16x16x32_bf16 v[52:55], v[164:167], v[68:71], v[52:55]
    s_waitcnt lgkmcnt(7)
    v_mfma_f32_16x16x32_bf16 v[48:51], v[152:155], v[72:75], v[48:51]
    v_mfma_f32_16x16x32_bf16 v[52:55], v[160:163], v[72:75], v[52:55]
    s_waitcnt lgkmcnt(6)
    v_mfma_f32_16x16x32_bf16 v[52:55], v[156:159], v[76:79], v[52:55]
    s_waitcnt lgkmcnt(5)
    v_mfma_f32_16x16x32_bf16 v[52:55], v[152:155], v[80:83], v[52:55]
ex_join:
    v_mfma_f32_16x16x32_bf16 v[24:27], a[152:155], v[88:91], v[24:27]
    ds_read_b128 v[56:59], v7 offset:1536
    v_mfma_f32_16x16x32_bf16 v[28:31], a[184:187], v[88:91], v[28:31]
    ds_read_b128 v[60:63], v7 offset:1024
    v_mfma_f32_16x16x32_bf16 v[32:35], a[216:219], v[88:91], v[32:35]
    ds_read_b128 v[64:67], v7 offset:1600
    buffer_load_dword v253, v233, s[56:59], 0 offen sc1
    v_mfma_f32_16x16x32_bf16 v[36:39], a[248:251], v[88:91], v[36:39]
    ds_read_b128 v[68:71], v7 offset:1088
    v_mfma_f32_16x16x32_bf16 v[24:27], a[120:123], v[92:95], v[24:27]
    v_mfma_f32_16x16x32_bf16 v[28:31], a[152:155], v[92:95], v[28:31]
    v_mfma_f32_16x16x32_bf16 v[32:35], a[184:187], v[92:95], v[32:35]
    v_mfma_f32_16x16x32_bf16 v[36:39], a[216:219], v[92:95], v[36:39]
    v_mfma_f32_16x16x32_bf16 v[24:27], a[88:91], v[96:99], v[24:27]
    ds_write_b128 v229, v[40:43] offset:0
    v_mfma_f32_16x16x32_bf16 v[28:31], a[120:123], v[96:99], v[28:31]
    ds_write_b128 v229, v[44:47] offset:4096
    v_mfma_f32_16x16x32_bf16 v[32:35], a[152:155], v[96:99], v[32:35]
    ds_write_b128 v229, v[48:51] offset:8192
    v_mfma_f32_16x16x32_bf16 v[36:39], a[184:187], v[96:99], v[36:39]
    ds_write_b128 v229, v[52:55] offset:12288
    v_mfma_f32_16x16x32_bf16 v[24:27], a[56:59], v[100:103], v[24:27]
    v_mfma_f32_16x16x32_bf16 v[28:31], a[88:91], v[100:103], v[28:31]
    v_mfma_f32_16x16x32_bf16 v[32:35], a[120:123], v[100:103], v[32:35]
    v_mfma_f32_16x16x32_bf16 v[36:39], a[152:155], v[100:103], v[36:39]
    v_mfma_f32_16x16x32_bf16 v[24:27], a[156:159], v[104:107], v[24:27]
    ds_read_b128 v[72:75], v7 offset:1664
    v_mfma_f32_16x16x32_bf16 v[28:31], a[188:191], v[104:107], v[28:31]
    ds_read_b128 v[76:79], v7 offset:1152
    s_waitcnt lgkmcnt(2)
    s_barrier
    v_mfma_f32_16x16x32_bf16 v[32:35], a[220:223], v[104:107], v[32:35]
    ds_read_b128 v[80:83], v7 offset:1728
    v_mfma_f32_16x16x32_bf16 v[36:39], a[252:255], v[104:107], v[36:39]
    ds_read_b128 v[84:87], v7 offset:1216
    v_mfma_f32_16x16x32_bf16 v[24:27], a[124:127], v[108:111], v[24:27]
    ds_read_b128 v[144:147], v225 offset:0
    v_mfma_f32_16x16x32_bf16 v[28:31], a[156:159], v[108:111], v[28:31]
    ds_read_b128 v[148:151], v225 offset:4608
    v_mfma_f32_16x16x32_bf16 v[32:35], a[188:191], v[108:111], v[32:35]
    ds_read_b128 v[120:123], v230 offset:0
    v_mfma_f32_16x16x32_bf16 v[36:39], a[220:223], v[108:111], v[36:39]
    ds_read_b128 v[124:127], v230 offset:1024
    v_mfma_f32_16x16x32_bf16 v[24:27], a[92:95], v[112:115], v[24:27]
    ds_read_b128 v[128:131], v230 offset:2048
    v_mfma_f32_16x16x32_bf16 v[28:31], a[124:127], v[112:115], v[28:31]
    ds_read_b128 v[132:135], v230 offset:3072
    v_mfma_f32_16x16x32_bf16 v[32:35], a[156:159], v[112:115], v[32:35]
    ds_read_b64 v[136:137], v231
    v_mfma_f32_16x16x32_bf16 v[36:39], a[188:191], v[112:115], v[36:39]
    v_mfma_f32_16x16x32_bf16 v[24:27], a[60:63], v[116:119], v[24:27]
    v_mfma_f32_16x16x32_bf16 v[28:31], a[92:95], v[116:119], v[28:31]
    v_mfma_f32_16x16x32_bf16 v[32:35], a[124:127], v[116:119], v[32:35]
    v_mfma_f32_16x16x32_bf16 v[36:39], a[156:159], v[116:119], v[36:39]
    v_mfma_f32_16x16x32_bf16 v[24:27], v[216:219], v[56:59], v[24:27]
    ds_read_b128 v[88:91], v7 offset:1792
    v_mfma_f32_16x16x32_bf16 v[24:27], a[0:3], v[56:59], v[24:27]
    ds_read_b128 v[92:95], v7 offset:1280
    v_mfma_f32_16x16x32_bf16 v[28:31], a[32:35], v[56:59], v[28:31]
    ds_read_b128 v[96:99], v7 offset:1856
    v_mfma_f32_16x16x32_bf16 v[28:31], v[216:219], v[60:63], v[28:31]
    ds_read_b128 v[100:103], v7 offset:1344
    v_mfma_f32_16x16x32_bf16 v[28:31], a[0:3], v[60:63], v[28:31]
    s_waitcnt lgkmcnt(4)
    v_pk_add_f32 v[120:121], v[120:121], v[124:125]
    v_pk_add_f32 v[122:123], v[122:123], v[126:127]
    v_mfma_f32_16x16x32_bf16 v[24:27], a[4:7], v[64:67], v[24:27]
    v_pk_add_f32 v[128:129], v[128:129], v[132:133]
    v_pk_add_f32 v[130:131], v[130:131], v[134:135]
    v_mfma_f32_16x16x32_bf16 v[28:31], a[36:39], v[64:67], v[28:31]
    v_pk_add_f32 v[120:121], v[120:121], v[128:129]
    v_pk_add_f32 v[122:123], v[122:123], v[130:131]
    v_mfma_f32_16x16x32_bf16 v[28:31], a[4:7], v[68:71], v[28:31]
    v_and_b32 v124, 0xffff0000, v137
    v_lshlrev_b32 v125, 16, v137
    v_mfma_f32_16x16x32_bf16 v[24:27], a[8:11], v[72:75], v[24:27]
    ds_read_b128 v[104:107], v7 offset:1920
    v_mfma_f32_16x16x32_bf16 v[28:31], a[40:43], v[72:75], v[28:31]
    ds_read_b128 v[108:111], v7 offset:1408
    v_mfma_f32_16x16x32_bf16 v[28:31], a[8:11], v[76:79], v[28:31]
    ds_read_b128 v[112:115], v7 offset:1984
    v_mfma_f32_16x16x32_bf16 v[24:27], a[12:15], v[80:83], v[24:27]
    ds_read_b128 v[116:119], v7 offset:1472
    v_mfma_f32_16x16x32_bf16 v[28:31], a[44:47], v[80:83], v[28:31]
    v_and_b32 v126, 0xffff0000, v136
    v_lshlrev_b32 v127, 16, v136
    v_mfma_f32_16x16x32_bf16 v[28:31], a[12:15], v[84:87], v[28:31]
    v_fmac_f32 v120, s78, v124
    v_fmac_f32 v121, s78, v125
    s_waitcnt lgkmcnt(7)
    v_mfma_f32_16x16x32_bf16 v[24:27], a[16:19], v[88:91], v[24:27]
    ds_read_b128 v[56:59], v7 offset:1536
    s_waitcnt vmcnt(0)
    v_cmp_ne_u32 vcc, s83, v253
    s_cbranch_vccnz c_slow
c_back:
    s_barrier
    v_mfma_f32_16x16x32_bf16 v[28:31], a[48:51], v[88:91], v[28:31]
    ds_read_b128 v[60:63], v7 offset:1024
    s_waitcnt lgkmcnt(8)
    v_mfma_f32_16x16x32_bf16 v[28:31], a[16:19], v[92:95], v[28:31]
    ds_read_b128 v[64:67], v7 offset:512
    s_waitcnt lgkmcnt(8)
    v_mfma_f32_16x16x32_bf16 v[24:27], a[20:23], v[96:99], v[24:27]
    ds_read_b128 v[68:71], v7 offset:0
    v_mfma_f32_16x16x32_bf16 v[28:31], a[52:55], v[96:99], v[28:31]
    s_add_u32 s3, s80, 0
    buffer_store_dwordx4 v[144:147], v3, s[44:47], s3 offen sc1
    s_waitcnt lgkmcnt(8)
    v_mfma_f32_16x16x32_bf16 v[28:31], a[20:23], v[100:103], v[28:31]
    s_add_u32 s3, s80, 1073152
    buffer_store_dwordx4 v[148:151], v3, s[44:47], s3 offen sc1
    s_waitcnt lgkmcnt(7)
    v_mfma_f32_16x16x32_bf16 v[24:27], a[24:27], v[104:107], v[24:27]
    ds_read_b128 v[72:75], v7 offset:1600
    v_mfma_f32_16x16x32_bf16 v[28:31], a[56:59], v[104:107], v[28:31]
    ds_read_b128 v[76:79], v7 offset:1088
    s_waitcnt lgkmcnt(8)
    v_mfma_f32_16x16x32_bf16 v[28:31], a[24:27], v[108:111], v[28:31]
    ds_read_b128 v[80:83], v7 offset:576
    s_waitcnt lgkmcnt(8)
    v_mfma_f32_16x16x32_bf16 v[24:27], a[28:31], v[112:115], v[24:27]
    ds_read_b128 v[84:87], v7 offset:64
    v_mfma_f32_16x16x32_bf16 v[28:31], a[60:63], v[112:115], v[28:31]
    v_fmac_f32 v122, s78, v126
    v_fmac_f32 v123, s78, v127
    s_waitcnt lgkmcnt(8)
    v_mfma_f32_16x16x32_bf16 v[28:31], a[28:31], v[116:119], v[28:31]
    v_cvt_pk_bf16_f32 v138, v120, v121
    v_cvt_pk_bf16_f32 v139, v122, v123
    s_waitcnt lgkmcnt(7)
    v_mfma_f32_16x16x32_bf16 v[32:35], a[64:67], v[56:59], v[32:35]
    ds_read_b128 v[88:91], v7 offset:1664
    v_mfma_f32_16x16x32_bf16 v[36:39], a[96:99], v[56:59], v[36:39]
    ds_read_b128 v[92:95], v7 offset:1152
    s_waitcnt lgkmcnt(8)
    v_mfma_f32_16x16x32_bf16 v[32:35], a[32:35], v[60:63], v[32:35]
    ds_read_b128 v[96:99], v7 offset:640
    v_mfma_f32_16x16x32_bf16 v[36:39], a[64:67], v[60:63], v[36:39]
    ds_read_b128 v[100:103], v7 offset:128
    s_waitcnt lgkmcnt(9)
    v_mfma_f32_16x16x32_bf16 v[32:35], v[216:219], v[64:67], v[32:35]
    v_min_u32 v138, -2, v138
    v_min_u32 v139, -2, v139
    v_mfma_f32_16x16x32_bf16 v[32:35], a[0:3], v[64:67], v[32:35]
    ds_write_b64 v227, v[138:139]
    v_mfma_f32_16x16x32_bf16 v[36:39], a[32:35], v[64:67], v[36:39]
    ds_read_b128 v[140:143], v228
    s_waitcnt lgkmcnt(10)
    v_mfma_f32_16x16x32_bf16 v[36:39], v[216:219], v[68:71], v[36:39]
    v_mfma_f32_16x16x32_bf16 v[36:39], a[0:3], v[68:71], v[36:39]
    v_cvt_pk_bf16_f32 v220, v24, v25
    v_cvt_pk_bf16_f32 v221, v26, v27
    s_waitcnt lgkmcnt(9)
    v_mfma_f32_16x16x32_bf16 v[32:35], a[68:71], v[72:75], v[32:35]
    ds_read_b128 v[104:107], v7 offset:1728
    v_mfma_f32_16x16x32_bf16 v[36:39], a[100:103], v[72:75], v[36:39]
    ds_read_b128 v[108:111], v7 offset:1216
    s_waitcnt lgkmcnt(10)
    v_mfma_f32_16x16x32_bf16 v[32:35], a[36:39], v[76:79], v[32:35]
    ds_read_b128 v[112:115], v7 offset:704
    v_mfma_f32_16x16x32_bf16 v[36:39], a[68:71], v[76:79], v[36:39]
    ds_read_b128 v[116:119], v7 offset:192
    s_waitcnt lgkmcnt(11)
    v_mfma_f32_16x16x32_bf16 v[32:35], a[4:7], v[80:83], v[32:35]
    s_waitcnt lgkmcnt(4)
    s_mov_b32 exec_hi, 0
    buffer_store_dwordx4 v[140:143], v4, s[44:47], s81 offen sc1
    s_mov_b64 exec, -1
    v_mfma_f32_16x16x32_bf16 v[36:39], a[36:39], v[80:83], v[36:39]
    v_min_u32 v220, -2, v220
    v_min_u32 v221, -2, v221
    v_mfma_f32_16x16x32_bf16 v[36:39], a[4:7], v[84:87], v[36:39]
    ds_write_b64 v224, v[220:221] offset:9216
    v_mfma_f32_16x16x32_bf16 v[32:35], a[72:75], v[88:91], v[32:35]
    ds_read_b128 v[56:59], v7 offset:1792
    v_mfma_f32_16x16x32_bf16 v[36:39], a[104:107], v[88:91], v[36:39]
    ds_read_b128 v[60:63], v7 offset:1280
    v_mfma_f32_16x16x32_bf16 v[32:35], a[40:43], v[92:95], v[32:35]
    ds_read_b128 v[64:67], v7 offset:768
    v_mfma_f32_16x16x32_bf16 v[36:39], a[72:75], v[92:95], v[36:39]
    ds_read_b128 v[68:71], v7 offset:256
    v_mfma_f32_16x16x32_bf16 v[32:35], a[8:11], v[96:99], v[32:35]
    v_cvt_pk_bf16_f32 v222, v28, v29
    v_cvt_pk_bf16_f32 v223, v30, v31
    v_mfma_f32_16x16x32_bf16 v[36:39], a[40:43], v[96:99], v[36:39]
    v_min_u32 v222, -2, v222
    v_min_u32 v223, -2, v223
    v_mfma_f32_16x16x32_bf16 v[36:39], a[8:11], v[100:103], v[36:39]
    ds_write_b64 v224, v[222:223] offset:11520
    s_waitcnt lgkmcnt(9)
    v_mfma_f32_16x16x32_bf16 v[32:35], a[76:79], v[104:107], v[32:35]
    ds_read_b128 v[72:75], v7 offset:1856
    v_mfma_f32_16x16x32_bf16 v[36:39], a[108:111], v[104:107], v[36:39]
    ds_read_b128 v[76:79], v7 offset:1344
    s_waitcnt lgkmcnt(10)
    v_mfma_f32_16x16x32_bf16 v[32:35], a[44:47], v[108:111], v[32:35]
    ds_read_b128 v[80:83], v7 offset:832
    v_mfma_f32_16x16x32_bf16 v[36:39], a[76:79], v[108:111], v[36:39]
    ds_read_b128 v[84:87], v7 offset:320
    s_waitcnt lgkmcnt(11)
    v_mfma_f32_16x16x32_bf16 v[32:35], a[12:15], v[112:115], v[32:35]
    s_waitcnt lgkmcnt(4)
    s_barrier
    v_mfma_f32_16x16x32_bf16 v[36:39], a[44:47], v[112:115], v[36:39]
    ds_read_b128 v[184:187], v225 offset:9216
    v_mfma_f32_16x16x32_bf16 v[36:39], a[12:15], v[116:119], v[36:39]
    v_mfma_f32_16x16x32_bf16 v[32:35], a[80:83], v[56:59], v[32:35]
    ds_read_b128 v[88:91], v7 offset:1920
    v_mfma_f32_16x16x32_bf16 v[36:39], a[112:115], v[56:59], v[36:39]
    ds_read_b128 v[92:95], v7 offset:1408
    v_mfma_f32_16x16x32_bf16 v[32:35], a[48:51], v[60:63], v[32:35]
    ds_read_b128 v[96:99], v7 offset:896
    v_mfma_f32_16x16x32_bf16 v[36:39], a[80:83], v[60:63], v[36:39]
    ds_read_b128 v[100:103], v7 offset:384
    v_mfma_f32_16x16x32_bf16 v[32:35], a[16:19], v[64:67], v[32:35]
    v_mfma_f32_16x16x32_bf16 v[36:39], a[48:51], v[64:67], v[36:39]
    v_mfma_f32_16x16x32_bf16 v[36:39], a[16:19], v[68:71], v[36:39]
    s_add_u32 s3, s80, 2146304
    s_waitcnt lgkmcnt(4)
    buffer_store_dwordx4 v[184:187], v3, s[44:47], s3 offen sc1
    v_mfma_f32_16x16x32_bf16 v[32:35], a[84:87], v[72:75], v[32:35]
    ds_read_b128 v[104:107], v7 offset:1984
    v_mfma_f32_16x16x32_bf16 v[36:39], a[116:119], v[72:75], v[36:39]
    ds_read_b128 v[108:111], v7 offset:1472
    v_mfma_f32_16x16x32_bf16 v[32:35], a[52:55], v[76:79], v[32:35]
    ds_read_b128 v[112:115], v7 offset:960
    v_mfma_f32_16x16x32_bf16 v[36:39], a[84:87], v[76:79], v[36:39]
    ds_read_b128 v[116:119], v7 offset:448
    v_mfma_f32_16x16x32_bf16 v[32:35], a[20:23], v[80:83], v[32:35]
    v_mfma_f32_16x16x32_bf16 v[36:39], a[52:55], v[80:83], v[36:39]
    v_mfma_f32_16x16x32_bf16 v[36:39], a[20:23], v[84:87], v[36:39]
    s_waitcnt lgkmcnt(7)
    v_mfma_f32_16x16x32_bf16 v[32:35], a[88:91], v[88:91], v[32:35]
    v_mfma_f32_16x16x32_bf16 v[36:39], a[120:123], v[88:91], v[36:39]
    s_waitcnt lgkmcnt(6)
    v_mfma_f32_16x16x32_bf16 v[32:35], a[56:59], v[92:95], v[32:35]
    v_mfma_f32_16x16x32_bf16 v[36:39], a[88:91], v[92:95], v[36:39]
    s_waitcnt lgkmcnt(5)
    v_mfma_f32_16x16x32_bf16 v[32:35], a[24:27], v[96:99], v[32:35]
    v_mfma_f32_16x16x32_bf16 v[36:39], a[56:59], v[96:99], v[36:39]
    s_waitcnt lgkmcnt(4)
    v_mfma_f32_16x16x32_bf16 v[36:39], a[24:27], v[100:103], v[36:39]
    s_waitcnt lgkmcnt(3)
    v_mfma_f32_16x16x32_bf16 v[32:35], a[92:95], v[104:107], v[32:35]
    s_waitcnt lgkmcnt(2)
    v_mfma_f32_16x16x32_bf16 v[32:35], a[60:63], v[108:111], v[32:35]
    s_waitcnt lgkmcnt(1)
    v_mfma_f32_16x16x32_bf16 v[32:35], a[28:31], v[112:115], v[32:35]
    v_mfma_f32_16x16x32_bf16 v[36:39], a[124:127], v[104:107], v[36:39]
    v_mfma_f32_16x16x32_bf16 v[36:39], a[92:95], v[108:111], v[36:39]
    v_mfma_f32_16x16x32_bf16 v[36:39], a[60:63], v[112:115], v[36:39]
    s_waitcnt lgkmcnt(0)
    v_mfma_f32_16x16x32_bf16 v[36:39], a[28:31], v[116:119], v[36:39]
    s_nop 3
    v_cvt_pk_bf16_f32 v220, v32, v33
    v_cvt_pk_bf16_f32 v221, v34, v35
    v_min_u32 v220, -2, v220
    v_min_u32 v221, -2, v221
    ds_write_b64 v224, v[220:221] offset:13824
    v_cvt_pk_bf16_f32 v222, v36, v37
    v_cvt_pk_bf16_f32 v223, v38, v39
    v_min_u32 v222, -2, v222
    v_min_u32 v223, -2, v223
    ds_write_b64 v224, v[222:223] offset:16128
    s_waitcnt lgkmcnt(0)
    s_barrier
    ds_read_b128 v[148:151], v225 offset:13824
    s_add_u32 s3, s80, 3219456
    s_waitcnt lgkmcnt(0)
    buffer_store_dwordx4 v[148:151], v3, s[44:47], s3 offen sc1
    v_lshlrev_b32 v8, 16, v240
    v_and_b32 v10, 0xffff0000, v240
    v_lshlrev_b32 v9, 16, v244
    v_and_b32 v11, 0xffff0000, v244
    v_lshlrev_b32 v12, 16, v241
    v_and_b32 v14, 0xffff0000, v241
    v_lshlrev_b32 v13, 16, v245
    v_and_b32 v15, 0xffff0000, v245
    v_lshlrev_b32 v16, 16, v242
    v_and_b32 v18, 0xffff0000, v242
    v_lshlrev_b32 v17, 16, v246
    v_and_b32 v19, 0xffff0000, v246
    v_lshlrev_b32 v20, 16, v243
    v_and_b32 v22, 0xffff0000, v243
    v_lshlrev_b32 v21, 16, v247
    v_and_b32 v23, 0xffff0000, v247
    v_lshlrev_b32 v24, 16, v248
    v_lshlrev_b32 v25, 16, v249
    v_readfirstlane_b32 s92, v8
    v_readfirstlane_b32 s93, v9
    s_nop 1
    v_mov_b32 v88, s92
    v_mov_b32 v89, s93
    v_pk_add_f32 v[8:9], v[8:9], v[88:89] neg_lo:[0,1] neg_hi:[0,1]
    v_pk_add_f32 v[10:11], v[10:11], v[88:89] neg_lo:[0,1] neg_hi:[0,1]
    v_pk_add_f32 v[12:13], v[12:13], v[88:89] neg_lo:[0,1] neg_hi:[0,1]
    v_pk_add_f32 v[14:15], v[14:15], v[88:89] neg_lo:[0,1] neg_hi:[0,1]
    v_pk_add_f32 v[16:17], v[16:17], v[88:89] neg_lo:[0,1] neg_hi:[0,1]
    v_pk_add_f32 v[18:19], v[18:19], v[88:89] neg_lo:[0,1] neg_hi:[0,1]
    v_pk_add_f32 v[20:21], v[20:21], v[88:89] neg_lo:[0,1] neg_hi:[0,1]
    v_pk_add_f32 v[22:23], v[22:23], v[88:89] neg_lo:[0,1] neg_hi:[0,1]
    v_pk_add_f32 v[24:25], v[24:25], v[88:89] neg_lo:[0,1] neg_hi:[0,1]
    v_pk_add_f32 v[80:81], v[8:9], v[10:11]
    v_pk_mul_f32 v[82:83], v[8:9], v[8:9]
    v_pk_fma_f32 v[82:83], v[10:11], v[10:11], v[82:83]
    v_pk_add_f32 v[80:81], v[80:81], v[12:13]
    v_pk_fma_f32 v[82:83], v[12:13], v[12:13], v[82:83]
    v_pk_add_f32 v[80:81], v[80:81], v[14:15]
    v_pk_fma_f32 v[82:83], v[14:15], v[14:15], v[82:83]
    v_pk_add_f32 v[80:81], v[80:81], v[16:17]
    v_pk_fma_f32 v[82:83], v[16:17], v[16:17], v[82:83]
    v_pk_add_f32 v[80:81], v[80:81], v[18:19]
    v_pk_fma_f32 v[82:83], v[18:19], v[18:19], v[82:83]
    v_pk_add_f32 v[80:81], v[80:81], v[20:21]
    v_pk_fma_f32 v[82:83], v[20:21], v[20:21], v[82:83]
    v_pk_add_f32 v[80:81], v[80:81], v[22:23]
    v_pk_fma_f32 v[82:83], v[22:23], v[22:23], v[82:83]
    v_pk_add_f32 v[80:81], v[80:81], v[24:25]
    v_pk_fma_f32 v[82:83], v[24:25], v[24:25], v[82:83]
    s_nop 0
    s_nop 0
    v_permlane32_swap_b32 v80, v81
    v_permlane32_swap_b32 v82, v83
    v_add_f32 v80, v80, v81
    v_add_f32 v82, v82, v83
    s_nop 0
    s_nop 0
    v_permlane16_swap_b32 v80, v82
    v_add_f32 v90, v80, v82
    s_nop 0
    s_nop 0
    v_add_f32_dpp v90, v90, v90 quad_perm:[1,0,3,2] row_mask:0xf bank_mask:0xf
    s_nop 0
    s_nop 0
    v_add_f32_dpp v90, v90, v90 quad_perm:[2,3,0,1] row_mask:0xf bank_mask:0xf
    s_nop 0
    s_nop 0
    v_add_f32_dpp v90, v90, v90 row_half_mirror row_mask:0xf bank_mask:0xf
    s_nop 0
    s_nop 0
    v_add_f32_dpp v90, v90, v90 row_mirror row_mask:0xf bank_mask:0xf
    v_mov_b32 v91, v90
    s_nop 0
    s_nop 0
    v_permlane16_swap_b32 v90, v91
    v_mul_f32 v90, s86, v90
    v_mul_f32 v91, s86, v91
    v_fma_f32 v91, -v90, v90, v91
    v_max_f32 v91, 0, v91
    v_add_f32 v91, s87, v91
    v_rsq_f32 v84, v91
    s_nop 0
    v_mul_f32 v86, v84, v90
    v_mov_b32 v85, v84
    v_mov_b32 v87, v86
    s_nop 0
    s_nop 0
    v_permlane32_swap_b32 v84, v85
    v_permlane32_swap_b32 v86, v87
    v_xor_b32 v120, 0, v235
    v_add_u32 v120, s98, v120
    v_xor_b32 v121, 4, v235
    v_add_u32 v121, s98, v121
    v_xor_b32 v122, 8, v235
    v_add_u32 v122, s98, v122
    v_xor_b32 v123, 12, v235
    v_add_u32 v123, s98, v123
    s_or_b32 s3, s2, s64
    s_cmp_eq_u32 s3, 0
    s_cbranch_scc0 no_epoch
    s_mov_b32 s3, 163840
    v_mov_b32 v238, s3
    v_mov_b32 v239, s83
    s_mov_b64 exec, 1
    buffer_store_dword v239, v238, s[56:59], 0 offen sc1
    s_mov_b64 exec, -1
no_epoch:
    s_mov_b64 s[4:5], -1
    s_mov_b64 s[6:7], -1
    s_mov_b64 s[8:9], -1
    s_mov_b64 s[10:11], -1
    s_mov_b32 s12, -1
    s_mov_b32 s13, 0
    s_mov_b32 s92, 0x20000
    s_waitcnt vmcnt(0)
    s_branch yc_load
yc_loop:
    s_waitcnt vmcnt(0)
yc_chk:
    s_mov_b64 exec, s[4:5]
    v_max3_u32 v238, v152, v153, v154
    v_max_u32 v238, v238, v155
    v_cmp_eq_u32 s[4:5], -1, v238
    s_mov_b64 exec, s[6:7]
    v_max3_u32 v238, v156, v157, v158
    v_max_u32 v238, v238, v159
    v_cmp_eq_u32 s[6:7], -1, v238
    s_mov_b64 exec, s[8:9]
    v_max3_u32 v238, v160, v161, v162
    v_max_u32 v238, v238, v163
    v_cmp_eq_u32 s[8:9], -1, v238
    s_mov_b64 exec, s[10:11]
    v_max3_u32 v238, v164, v165, v166
    v_max_u32 v238, v238, v167
    v_cmp_eq_u32 s[10:11], -1, v238
    s_mov_b64 exec, s[12:13]
    v_max3_u32 v238, v168, v169, v170
    v_max_u32 v238, v238, v171
    v_cmp_eq_u32 s[12:13], -1, v238
    s_or_b64 s[14:15], s[4:5], s[6:7]
    s_or_b64 s[14:15], s[14:15], s[8:9]
    s_or_b64 s[14:15], s[14:15], s[10:11]
    s_or_b64 s[14:15], s[14:15], s[12:13]
    s_cbranch_scc0 yc_done
    s_sub_u32 s92, s92, 1
    s_cbranch_scc1 yc_done
yc_load:
    s_mov_b64 exec, s[4:5]
    s_cbranch_execz yc_skip0
    buffer_load_dwordx4 v[152:155], v251, s[44:47], s88 offen offset:0 sc1
yc_skip0:
    s_mov_b64 exec, s[6:7]
    s_cbranch_execz yc_skip1
    buffer_load_dwordx4 v[156:159], v251, s[44:47], s88 offen offset:1024 sc1
yc_skip1:
    s_mov_b64 exec, s[8:9]
    s_cbranch_execz yc_skip2
    buffer_load_dwordx4 v[160:163], v251, s[44:47], s88 offen offset:2048 sc1
yc_skip2:
    s_mov_b64 exec, s[10:11]
    s_cbranch_execz yc_skip3
    buffer_load_dwordx4 v[164:167], v251, s[44:47], s88 offen offset:3072 sc1
yc_skip3:
    s_mov_b64 exec, s[12:13]
    s_cbranch_execz yc_skip4
    buffer_load_dwordx4 v[168:171], v236, s[44:47], s89 offen sc1
yc_skip4:
    s_branch yc_loop
yc_done:
    s_mov_b64 exec, -1
    ds_write2_b32 v234, v152, v153 offset0:0 offset1:1
    ds_write2_b32 v234, v154, v155 offset0:2 offset1:3
    ds_write2_b32 v234, v156, v157 offset0:33 offset1:32
    ds_write2_b32 v234, v158, v159 offset0:35 offset1:34
    ds_write2_b32 v234, v160, v161 offset0:66 offset1:67
    ds_write2_b32 v234, v162, v163 offset0:64 offset1:65
    ds_write2_b32 v234, v164, v165 offset0:99 offset1:98
    ds_write2_b32 v234, v166, v167 offset0:97 offset1:96
    s_mov_b32 exec_hi, 0
    ds_write_b32 v120, v168
    ds_write_b32 v121, v169
    ds_write_b32 v122, v170
    ds_write_b32 v123, v171
    s_mov_b64 exec, -1
    s_waitcnt lgkmcnt(0)
    s_barrier
    ds_read_b32 v96, v237 offset:0
    ds_read_b32 v97, v237 offset:1028
    ds_read_b32 v98, v237 offset:2056
    ds_read_b32 v99, v237 offset:3084
    ds_read_b32 v100, v237 offset:4112
    ds_read_b32 v101, v237 offset:5140
    ds_read_b32 v102, v237 offset:6168
    ds_read_b32 v103, v237 offset:7196
    ds_read_b32 v104, v237 offset:8224
    ds_read_b32 v105, v237 offset:9264
    ds_read_b32 v106, v237 offset:10292
    ds_read_b32 v107, v237 offset:11320
    ds_read_b32 v108, v237 offset:12348
    ds_read_b32 v109, v237 offset:13376
    ds_read_b32 v110, v237 offset:14404
    ds_read_b32 v111, v237 offset:15432
    ds_read_b32 v112, v237 offset:16460
    ds_read_b32 v113, v237 offset:17488
p2_body:
    s_waitcnt lgkmcnt(15)
    v_lshlrev_b32 v26, 16, v96
    v_and_b32 v27, 0xffff0000, v96
    v_pk_mul_f32 v[62:63], v[8:9], v[26:27]
    s_waitcnt lgkmcnt(15)
    v_lshlrev_b32 v28, 16, v97
    v_and_b32 v29, 0xffff0000, v97
    v_pk_mul_f32 v[64:65], v[10:11], v[28:29]
    s_waitcnt lgkmcnt(15)
    v_lshlrev_b32 v30, 16, v98
    v_and_b32 v31, 0xffff0000, v98
    v_pk_mul_f32 v[66:67], v[12:13], v[30:31]
    s_waitcnt lgkmcnt(14)
    v_lshlrev_b32 v32, 16, v99
    v_and_b32 v33, 0xffff0000, v99
    v_pk_mul_f32 v[68:69], v[14:15], v[32:33]
    s_waitcnt lgkmcnt(13)
    v_lshlrev_b32 v34, 16, v100
    v_and_b32 v35, 0xffff0000, v100
    v_pk_mul_f32 v[70:71], v[16:17], v[34:35]
    s_waitcnt lgkmcnt(12)
    v_lshlrev_b32 v36, 16, v101
    v_and_b32 v37, 0xffff0000, v101
    v_pk_mul_f32 v[72:73], v[18:19], v[36:37]
    s_waitcnt lgkmcnt(11)
    v_lshlrev_b32 v38, 16, v102
    v_and_b32 v39, 0xffff0000, v102
    v_pk_mul_f32 v[74:75], v[20:21], v[38:39]
    s_waitcnt lgkmcnt(10)
    v_lshlrev_b32 v40, 16, v103
    v_and_b32 v41, 0xffff0000, v103
    v_pk_mul_f32 v[76:77], v[22:23], v[40:41]
    s_waitcnt lgkmcnt(9)
    v_lshlrev_b32 v42, 16, v104
    v_and_b32 v43, 0xffff0000, v104
    v_pk_mul_f32 v[78:79], v[24:25], v[42:43]
    v_pk_fma_f32 v[8:9], v[62:63], v[84:85], v[8:9]
    v_pk_fma_f32 v[10:11], v[64:65], v[84:85], v[10:11]
    v_pk_fma_f32 v[12:13], v[66:67], v[84:85], v[12:13]
    v_pk_fma_f32 v[14:15], v[68:69], v[84:85], v[14:15]
    v_pk_fma_f32 v[16:17], v[70:71], v[84:85], v[16:17]
    v_pk_fma_f32 v[18:19], v[72:73], v[84:85], v[18:19]
    v_pk_fma_f32 v[20:21], v[74:75], v[84:85], v[20:21]
    v_pk_fma_f32 v[22:23], v[76:77], v[84:85], v[22:23]
    v_pk_fma_f32 v[24:25], v[78:79], v[84:85], v[24:25]
    v_pk_fma_f32 v[8:9], v[26:27], v[86:87], v[8:9] neg_lo:[0,1,0] neg_hi:[0,1,0]
    v_pk_fma_f32 v[10:11], v[28:29], v[86:87], v[10:11] neg_lo:[0,1,0] neg_hi:[0,1,0]
    v_pk_fma_f32 v[12:13], v[30:31], v[86:87], v[12:13] neg_lo:[0,1,0] neg_hi:[0,1,0]
    v_pk_fma_f32 v[14:15], v[32:33], v[86:87], v[14:15] neg_lo:[0,1,0] neg_hi:[0,1,0]
    v_pk_fma_f32 v[16:17], v[34:35], v[86:87], v[16:17] neg_lo:[0,1,0] neg_hi:[0,1,0]
    v_pk_fma_f32 v[18:19], v[36:37], v[86:87], v[18:19] neg_lo:[0,1,0] neg_hi:[0,1,0]
    v_pk_fma_f32 v[20:21], v[38:39], v[86:87], v[20:21] neg_lo:[0,1,0] neg_hi:[0,1,0]
    v_pk_fma_f32 v[22:23], v[40:41], v[86:87], v[22:23] neg_lo:[0,1,0] neg_hi:[0,1,0]
    v_pk_fma_f32 v[24:25], v[42:43], v[86:87], v[24:25] neg_lo:[0,1,0] neg_hi:[0,1,0]
    s_waitcnt lgkmcnt(0)
    v_pk_add_f32 v[80:81], v[8:9], v[10:11]
    v_pk_mul_f32 v[82:83], v[8:9], v[8:9]
    v_pk_fma_f32 v[82:83], v[10:11], v[10:11], v[82:83]
    v_pk_add_f32 v[80:81], v[80:81], v[12:13]
    v_pk_fma_f32 v[82:83], v[12:13], v[12:13], v[82:83]
    v_pk_add_f32 v[80:81], v[80:81], v[14:15]
    v_pk_fma_f32 v[82:83], v[14:15], v[14:15], v[82:83]
    v_pk_add_f32 v[80:81], v[80:81], v[16:17]
    v_pk_fma_f32 v[82:83], v[16:17], v[16:17], v[82:83]
    v_pk_add_f32 v[80:81], v[80:81], v[18:19]
    v_pk_fma_f32 v[82:83], v[18:19], v[18:19], v[82:83]
    v_pk_add_f32 v[80:81], v[80:81], v[20:21]
    v_pk_fma_f32 v[82:83], v[20:21], v[20:21], v[82:83]
    v_pk_add_f32 v[80:81], v[80:81], v[22:23]
    v_pk_fma_f32 v[82:83], v[22:23], v[22:23], v[82:83]
    v_pk_add_f32 v[80:81], v[80:81], v[24:25]
    v_pk_fma_f32 v[82:83], v[24:25], v[24:25], v[82:83]
    v_lshlrev_b32 v44, 16, v105
    v_and_b32 v45, 0xffff0000, v105
    v_permlane32_swap_b32 v80, v81
    v_permlane32_swap_b32 v82, v83
    v_add_f32 v80, v80, v81
    v_add_f32 v82, v82, v83
    v_pk_mul_f32 v[62:63], v[8:9], v[44:45]
    v_lshlrev_b32 v46, 16, v106
    v_permlane16_swap_b32 v80, v82
    v_add_f32 v90, v80, v82
    v_and_b32 v47, 0xffff0000, v106
    v_pk_mul_f32 v[64:65], v[10:11], v[46:47]
    v_add_f32_dpp v90, v90, v90 quad_perm:[1,0,3,2] row_mask:0xf bank_mask:0xf
    v_lshlrev_b32 v48, 16, v107
    v_and_b32 v49, 0xffff0000, v107
    v_add_f32_dpp v90, v90, v90 quad_perm:[2,3,0,1] row_mask:0xf bank_mask:0xf
    v_pk_mul_f32 v[66:67], v[12:13], v[48:49]
    v_lshlrev_b32 v50, 16, v108
    v_add_f32_dpp v90, v90, v90 row_half_mirror row_mask:0xf bank_mask:0xf
    v_and_b32 v51, 0xffff0000, v108
    v_pk_mul_f32 v[68:69], v[14:15], v[50:51]
    v_add_f32_dpp v90, v90, v90 row_mirror row_mask:0xf bank_mask:0xf
    v_mov_b32 v91, v90
    v_lshlrev_b32 v52, 16, v109
    v_and_b32 v53, 0xffff0000, v109
    v_permlane16_swap_b32 v90, v91
    v_mul_f32 v90, s86, v90
    v_mul_f32 v91, s86, v91
    v_fma_f32 v91, -v90, v90, v91
    v_max_f32 v91, 0, v91
    v_add_f32 v91, s87, v91
    v_rsq_f32 v84, v91
    v_pk_mul_f32 v[70:71], v[16:17], v[52:53]
    v_mul_f32 v86, v84, v90
    v_mov_b32 v85, v84
    v_mov_b32 v87, v86
    v_lshlrev_b32 v54, 16, v110
    v_and_b32 v55, 0xffff0000, v110
    v_permlane32_swap_b32 v84, v85
    v_permlane32_swap_b32 v86, v87
    v_pk_mul_f32 v[72:73], v[18:19], v[54:55]
    v_lshlrev_b32 v56, 16, v111
    v_and_b32 v57, 0xffff0000, v111
    v_pk_mul_f32 v[74:75], v[20:21], v[56:57]
    v_lshlrev_b32 v58, 16, v112
    v_and_b32 v59, 0xffff0000, v112
    v_pk_mul_f32 v[76:77], v[22:23], v[58:59]
    v_lshlrev_b32 v60, 16, v113
    v_and_b32 v61, 0xffff0000, v113
    v_pk_mul_f32 v[78:79], v[24:25], v[60:61]
    s_nop 0
    v_pk_fma_f32 v[8:9], v[62:63], v[84:85], v[8:9]
    v_pk_fma_f32 v[10:11], v[64:65], v[84:85], v[10:11]
    v_pk_fma_f32 v[12:13], v[66:67], v[84:85], v[12:13]
    v_pk_fma_f32 v[14:15], v[68:69], v[84:85], v[14:15]
    v_pk_fma_f32 v[16:17], v[70:71], v[84:85], v[16:17]
    v_pk_fma_f32 v[18:19], v[72:73], v[84:85], v[18:19]
    v_pk_fma_f32 v[20:21], v[74:75], v[84:85], v[20:21]
    v_pk_fma_f32 v[22:23], v[76:77], v[84:85], v[22:23]
    v_pk_fma_f32 v[24:25], v[78:79], v[84:85], v[24:25]
    v_pk_fma_f32 v[8:9], v[44:45], v[86:87], v[8:9] neg_lo:[0,1,0] neg_hi:[0,1,0]
    v_pk_fma_f32 v[10:11], v[46:47], v[86:87], v[10:11] neg_lo:[0,1,0] neg_hi:[0,1,0]
    v_pk_fma_f32 v[12:13], v[48:49], v[86:87], v[12:13] neg_lo:[0,1,0] neg_hi:[0,1,0]
    v_pk_fma_f32 v[14:15], v[50:51], v[86:87], v[14:15] neg_lo:[0,1,0] neg_hi:[0,1,0]
    v_pk_fma_f32 v[16:17], v[52:53], v[86:87], v[16:17] neg_lo:[0,1,0] neg_hi:[0,1,0]
    v_pk_fma_f32 v[18:19], v[54:55], v[86:87], v[18:19] neg_lo:[0,1,0] neg_hi:[0,1,0]
    v_pk_fma_f32 v[20:21], v[56:57], v[86:87], v[20:21] neg_lo:[0,1,0] neg_hi:[0,1,0]
    v_pk_fma_f32 v[22:23], v[58:59], v[86:87], v[22:23] neg_lo:[0,1,0] neg_hi:[0,1,0]
    v_pk_fma_f32 v[24:25], v[60:61], v[86:87], v[24:25] neg_lo:[0,1,0] neg_hi:[0,1,0]
    v_pk_add_f32 v[80:81], v[8:9], v[10:11]
    v_pk_mul_f32 v[82:83], v[8:9], v[8:9]
    v_pk_fma_f32 v[82:83], v[10:11], v[10:11], v[82:83]
    v_pk_add_f32 v[80:81], v[80:81], v[12:13]
    v_pk_fma_f32 v[82:83], v[12:13], v[12:13], v[82:83]
    v_pk_add_f32 v[80:81], v[80:81], v[14:15]
    v_pk_fma_f32 v[82:83], v[14:15], v[14:15], v[82:83]
    v_pk_add_f32 v[80:81], v[80:81], v[16:17]
    v_pk_fma_f32 v[82:83], v[16:17], v[16:17], v[82:83]
    v_pk_add_f32 v[80:81], v[80:81], v[18:19]
    v_pk_fma_f32 v[82:83], v[18:19], v[18:19], v[82:83]
    v_pk_add_f32 v[80:81], v[80:81], v[20:21]
    v_pk_fma_f32 v[82:83], v[20:21], v[20:21], v[82:83]
    v_pk_add_f32 v[80:81], v[80:81], v[22:23]
    v_pk_fma_f32 v[82:83], v[22:23], v[22:23], v[82:83]
    v_pk_add_f32 v[80:81], v[80:81], v[24:25]
    v_pk_fma_f32 v[82:83], v[24:25], v[24:25], v[82:83]
    v_pk_mul_f32 v[62:63], v[8:9], v[26:27]
    v_pk_mul_f32 v[64:65], v[10:11], v[28:29]
    v_permlane32_swap_b32 v80, v81
    v_permlane32_swap_b32 v82, v83
    v_add_f32 v80, v80, v81
    v_add_f32 v82, v82, v83
    v_pk_mul_f32 v[66:67], v[12:13], v[30:31]
    v_pk_mul_f32 v[68:69], v[14:15], v[32:33]
    v_permlane16_swap_b32 v80, v82
    v_add_f32 v90, v80, v82
    v_pk_mul_f32 v[70:71], v[16:17], v[34:35]
    v_pk_mul_f32 v[72:73], v[18:19], v[36:37]
    v_add_f32_dpp v90, v90, v90 quad_perm:[1,0,3,2] row_mask:0xf bank_mask:0xf
    v_pk_mul_f32 v[74:75], v[20:21], v[38:39]
    v_pk_mul_f32 v[76:77], v[22:23], v[40:41]
    v_add_f32_dpp v90, v90, v90 quad_perm:[2,3,0,1] row_mask:0xf bank_mask:0xf
    v_pk_mul_f32 v[78:79], v[24:25], v[42:43]
    s_nop 0
    v_add_f32_dpp v90, v90, v90 row_half_mirror row_mask:0xf bank_mask:0xf
    s_nop 0
    s_nop 0
    v_add_f32_dpp v90, v90, v90 row_mirror row_mask:0xf bank_mask:0xf
    v_mov_b32 v91, v90
    s_nop 0
    s_nop 0
    v_permlane16_swap_b32 v90, v91
    v_mul_f32 v90, s86, v90
    v_mul_f32 v91, s86, v91
    v_fma_f32 v91, -v90, v90, v91
    v_max_f32 v91, 0, v91
    v_add_f32 v91, s87, v91
    v_rsq_f32 v84, v91
    s_nop 0
    v_mul_f32 v86, v84, v90
    v_mov_b32 v85, v84
    v_mov_b32 v87, v86
    s_nop 0
    s_nop 0
    v_permlane32_swap_b32 v84, v85
    v_permlane32_swap_b32 v86, v87
    s_nop 0
    v_pk_fma_f32 v[8:9], v[62:63], v[84:85], v[8:9]
    v_pk_fma_f32 v[10:11], v[64:65], v[84:85], v[10:11]
    v_pk_fma_f32 v[12:13], v[66:67], v[84:85], v[12:13]
    v_pk_fma_f32 v[14:15], v[68:69], v[84:85], v[14:15]
    v_pk_fma_f32 v[16:17], v[70:71], v[84:85], v[16:17]
    v_pk_fma_f32 v[18:19], v[72:73], v[84:85], v[18:19]
    v_pk_fma_f32 v[20:21], v[74:75], v[84:85], v[20:21]
    v_pk_fma_f32 v[22:23], v[76:77], v[84:85], v[22:23]
    v_pk_fma_f32 v[24:25], v[78:79], v[84:85], v[24:25]
    v_pk_fma_f32 v[8:9], v[26:27], v[86:87], v[8:9] neg_lo:[0,1,0] neg_hi:[0,1,0]
    v_pk_fma_f32 v[10:11], v[28:29], v[86:87], v[10:11] neg_lo:[0,1,0] neg_hi:[0,1,0]
    v_pk_fma_f32 v[12:13], v[30:31], v[86:87], v[12:13] neg_lo:[0,1,0] neg_hi:[0,1,0]
    v_pk_fma_f32 v[14:15], v[32:33], v[86:87], v[14:15] neg_lo:[0,1,0] neg_hi:[0,1,0]
    v_pk_fma_f32 v[16:17], v[34:35], v[86:87], v[16:17] neg_lo:[0,1,0] neg_hi:[0,1,0]
    v_pk_fma_f32 v[18:19], v[36:37], v[86:87], v[18:19] neg_lo:[0,1,0] neg_hi:[0,1,0]
    v_pk_fma_f32 v[20:21], v[38:39], v[86:87], v[20:21] neg_lo:[0,1,0] neg_hi:[0,1,0]
    v_pk_fma_f32 v[22:23], v[40:41], v[86:87], v[22:23] neg_lo:[0,1,0] neg_hi:[0,1,0]
    v_pk_fma_f32 v[24:25], v[42:43], v[86:87], v[24:25] neg_lo:[0,1,0] neg_hi:[0,1,0]
    v_pk_add_f32 v[80:81], v[8:9], v[10:11]
    v_pk_mul_f32 v[82:83], v[8:9], v[8:9]
    v_pk_fma_f32 v[82:83], v[10:11], v[10:11], v[82:83]
    v_pk_add_f32 v[80:81], v[80:81], v[12:13]
    v_pk_fma_f32 v[82:83], v[12:13], v[12:13], v[82:83]
    v_pk_add_f32 v[80:81], v[80:81], v[14:15]
    v_pk_fma_f32 v[82:83], v[14:15], v[14:15], v[82:83]
    v_pk_add_f32 v[80:81], v[80:81], v[16:17]
    v_pk_fma_f32 v[82:83], v[16:17], v[16:17], v[82:83]
    v_pk_add_f32 v[80:81], v[80:81], v[18:19]
    v_pk_fma_f32 v[82:83], v[18:19], v[18:19], v[82:83]
    v_pk_add_f32 v[80:81], v[80:81], v[20:21]
    v_pk_fma_f32 v[82:83], v[20:21], v[20:21], v[82:83]
    v_pk_add_f32 v[80:81], v[80:81], v[22:23]
    v_pk_fma_f32 v[82:83], v[22:23], v[22:23], v[82:83]
    v_pk_add_f32 v[80:81], v[80:81], v[24:25]
    v_pk_fma_f32 v[82:83], v[24:25], v[24:25], v[82:83]
    v_pk_mul_f32 v[62:63], v[8:9], v[44:45]
    v_pk_mul_f32 v[64:65], v[10:11], v[46:47]
    v_permlane32_swap_b32 v80, v81
    v_permlane32_swap_b32 v82, v83
    v_add_f32 v80, v80, v81
    v_add_f32 v82, v82, v83
    v_pk_mul_f32 v[66:67], v[12:13], v[48:49]
    v_pk_mul_f32 v[68:69], v[14:15], v[50:51]
    v_permlane16_swap_b32 v80, v82
    v_add_f32 v90, v80, v82
    v_pk_mul_f32 v[70:71], v[16:17], v[52:53]
    v_pk_mul_f32 v[72:73], v[18:19], v[54:55]
    v_add_f32_dpp v90, v90, v90 quad_perm:[1,0,3,2] row_mask:0xf bank_mask:0xf
    v_pk_mul_f32 v[74:75], v[20:21], v[56:57]
    v_pk_mul_f32 v[76:77], v[22:23], v[58:59]
    v_add_f32_dpp v90, v90, v90 quad_perm:[2,3,0,1] row_mask:0xf bank_mask:0xf
    v_pk_mul_f32 v[78:79], v[24:25], v[60:61]
    v_pk_add_f32 v[8:9], v[8:9], v[88:89]
    v_add_f32_dpp v90, v90, v90 row_half_mirror row_mask:0xf bank_mask:0xf
    v_pk_add_f32 v[10:11], v[10:11], v[88:89]
    v_pk_add_f32 v[12:13], v[12:13], v[88:89]
    v_add_f32_dpp v90, v90, v90 row_mirror row_mask:0xf bank_mask:0xf
    v_mov_b32 v91, v90
    v_pk_add_f32 v[14:15], v[14:15], v[88:89]
    v_pk_add_f32 v[16:17], v[16:17], v[88:89]
    v_permlane16_swap_b32 v90, v91
    v_mul_f32 v90, s86, v90
    v_mul_f32 v91, s86, v91
    v_fma_f32 v91, -v90, v90, v91
    v_max_f32 v91, 0, v91
    v_add_f32 v91, s87, v91
    v_rsq_f32 v84, v91
    v_pk_add_f32 v[18:19], v[18:19], v[88:89]
    v_mul_f32 v86, v84, v90
    v_mov_b32 v85, v84
    v_mov_b32 v87, v86
    v_pk_add_f32 v[20:21], v[20:21], v[88:89]
    v_pk_add_f32 v[22:23], v[22:23], v[88:89]
    v_permlane32_swap_b32 v84, v85
    v_permlane32_swap_b32 v86, v87
    v_pk_add_f32 v[24:25], v[24:25], v[88:89]
    s_nop 0
    v_pk_fma_f32 v[8:9], v[62:63], v[84:85], v[8:9]
    v_pk_fma_f32 v[10:11], v[64:65], v[84:85], v[10:11]
    v_pk_fma_f32 v[12:13], v[66:67], v[84:85], v[12:13]
    v_pk_fma_f32 v[14:15], v[68:69], v[84:85], v[14:15]
    v_pk_fma_f32 v[16:17], v[70:71], v[84:85], v[16:17]
    v_pk_fma_f32 v[18:19], v[72:73], v[84:85], v[18:19]
    v_pk_fma_f32 v[20:21], v[74:75], v[84:85], v[20:21]
    v_pk_fma_f32 v[22:23], v[76:77], v[84:85], v[22:23]
    v_pk_fma_f32 v[24:25], v[78:79], v[84:85], v[24:25]
    v_pk_fma_f32 v[8:9], v[44:45], v[86:87], v[8:9] neg_lo:[0,1,0] neg_hi:[0,1,0]
    v_pk_fma_f32 v[10:11], v[46:47], v[86:87], v[10:11] neg_lo:[0,1,0] neg_hi:[0,1,0]
    v_pk_fma_f32 v[12:13], v[48:49], v[86:87], v[12:13] neg_lo:[0,1,0] neg_hi:[0,1,0]
    v_pk_fma_f32 v[14:15], v[50:51], v[86:87], v[14:15] neg_lo:[0,1,0] neg_hi:[0,1,0]
    v_pk_fma_f32 v[16:17], v[52:53], v[86:87], v[16:17] neg_lo:[0,1,0] neg_hi:[0,1,0]
    v_pk_fma_f32 v[18:19], v[54:55], v[86:87], v[18:19] neg_lo:[0,1,0] neg_hi:[0,1,0]
    v_pk_fma_f32 v[20:21], v[56:57], v[86:87], v[20:21] neg_lo:[0,1,0] neg_hi:[0,1,0]
    v_pk_fma_f32 v[22:23], v[58:59], v[86:87], v[22:23] neg_lo:[0,1,0] neg_hi:[0,1,0]
    v_pk_fma_f32 v[24:25], v[60:61], v[86:87], v[24:25] neg_lo:[0,1,0] neg_hi:[0,1,0]
    v_cvt_pk_bf16_f32 v240, v8, v10
    v_cvt_pk_bf16_f32 v241, v12, v14
    v_cvt_pk_bf16_f32 v242, v16, v18
    v_cvt_pk_bf16_f32 v243, v20, v22
    v_cvt_pk_bf16_f32 v244, v9, v11
    v_cvt_pk_bf16_f32 v245, v13, v15
    v_cvt_pk_bf16_f32 v246, v17, v19
    v_cvt_pk_bf16_f32 v247, v21, v23
    v_cvt_pk_bf16_f32 v248, v24, v25
    buffer_store_dwordx4 v[240:243], v251, s[52:55], s84 offen sc1
    buffer_store_dwordx4 v[244:247], v251, s[52:55], s84 offen offset:1152 sc1
    buffer_store_short v248, v252, s[52:55], s84 offen offset:1024 sc1
    buffer_store_short_d16_hi v248, v252, s[52:55], s84 offen offset:2176 sc1
    s_endpgm
c_slow:
    s_mov_b32 s92, 0x20000
c_spin:
    s_sleep 4
    buffer_load_dword v253, v233, s[56:59], 0 offen sc1
    s_waitcnt vmcnt(0)
    v_cmp_ne_u32 vcc, s83, v253
    s_sub_u32 s92, s92, 1
    s_cbranch_scc1 c_back
    s_cbranch_vccnz c_spin
    s_branch c_back
interleave_layers__ssm_conv_h3__ssm_conv_h3__prompt_kernel_end:
    s_endpgm
.section .rodata,"a"
.p2align 6
.amdhsa_kernel interleave_layers__ssm_conv_h3__ssm_conv_h3__prompt_kernel
  .amdhsa_next_free_vgpr 512
  .amdhsa_next_free_sgpr 102
  .amdhsa_accum_offset 256
  .amdhsa_group_segment_fixed_size 0
  .amdhsa_kernarg_size 120
  .amdhsa_user_sgpr_count 2
  .amdhsa_user_sgpr_kernarg_segment_ptr 1
  .amdhsa_system_sgpr_workgroup_id_x 1
.end_amdhsa_kernel
```
